```python
import torch

def _softmax(x, axis=-1):
    return torch.softmax(x, dim=axis)
def _gelu(x):
    return torch.nn.functional.gelu(x, approximate="tanh")
def _silu(x):
    return torch.nn.functional.silu(x)
def _sigmoid(x):
    return torch.sigmoid(x)
def _layernorm(x, axis=-1, eps=1e-5):
    m = x.mean(dim=axis, keepdim=True)
    v = x.var(dim=axis, keepdim=True, unbiased=False)
    return (x - m) / torch.sqrt(v + eps)
def _scatter_add(tgt, idx, src, axis=0):
    return tgt.clone().index_add_(axis, idx, src)
def _segment_sum(src, seg, n):
    out = torch.zeros((n,) + src.shape[1:], dtype=src.dtype)
    return out.index_add_(0, seg, src)
def _pad(x, pw):
    flat = tuple(v for pair in reversed(pw) for v in pair)
    return torch.nn.functional.pad(x, flat)

kernel_name = 'interleave_layers__ssm_conv_s4__sliding_local_dilated__prompt'

def setup_inputs():

    _w = (lambda a: (lambda t: t.to(torch.bfloat16) if t.is_floating_point() else t)(torch.as_tensor(a)))
    def _A_setup():
        B, L, D, N = 1, 2048, 512, 128
        A_re = -(lambda _x: torch.exp(torch.as_tensor(_x)))((lambda *s: torch.randn(*s, dtype=torch.bfloat16) * 1.6)(D, N))
        A_im = torch.pi * (lambda *s: torch.randn(*s, dtype=torch.bfloat16) * 0.1)(D, N)
        B_re = (lambda *s: torch.randn(*s, dtype=torch.bfloat16) * 0.1)(D, N)
        B_im = (lambda *s: torch.randn(*s, dtype=torch.bfloat16) * 0.1)(D, N)
        C_re = (lambda *s: torch.randn(*s, dtype=torch.bfloat16) * 0.1)(D, N)
        C_im = (lambda *s: torch.randn(*s, dtype=torch.bfloat16) * 0.1)(D, N)
        log_dt = (lambda *s: torch.randn(*s, dtype=torch.bfloat16) * 0.1)(D) * 0.5 - 4.0
        Dskip = (lambda *s: torch.randn(*s, dtype=torch.bfloat16) * 0.1)(D)
        return {
            "u": _w((lambda *s: torch.randn(*s, dtype=torch.bfloat16) * 0.05)(B, L, D)),
            "A_re": _w(A_re),
            "A_im": _w(A_im),
            "B_re": _w(B_re),
            "B_im": _w(B_im),
            "C_re": _w(C_re),
            "C_im": _w(C_im),
            "log_dt": _w(log_dt),
            "Dskip": _w(Dskip),
        }
    _A_in = _A_setup()

    def _B_setup():
        B, S, D = 1, 2048, 512
        return {
            "x": _w((lambda *s: torch.randn(*s, dtype=torch.bfloat16) * 0.05)(B, S, D)),
            "wqkv": _w((lambda *s: torch.randn(*s, dtype=torch.bfloat16) * 0.05)(D, 3 * D)),
            "wo": _w((lambda *s: torch.randn(*s, dtype=torch.bfloat16) * 0.05)(D, D)),
        }
    _B_in = _B_setup()

    return {
        "A_u": _A_in["u"],
        "A_A_re": _A_in["A_re"],
        "A_A_im": _A_in["A_im"],
        "A_B_re": _A_in["B_re"],
        "A_B_im": _A_in["B_im"],
        "A_C_re": _A_in["C_re"],
        "A_C_im": _A_in["C_im"],
        "A_log_dt": _A_in["log_dt"],
        "A_Dskip": _A_in["Dskip"],
        "B_x": _B_in["x"],
        "B_wqkv": _B_in["wqkv"],
        "B_wo": _B_in["wo"],
    }

def reference(A_u, A_A_re, A_A_im, A_B_re, A_B_im, A_C_re, A_C_im, A_log_dt, A_Dskip, B_x, B_wqkv, B_wo):
    def _A_ref(u, A_re, A_im, B_re, B_im, C_re, C_im, log_dt, Dskip):
        Bsz, L, D = u.shape
        dt = torch.exp(log_dt)[:, None]
        A = A_re + 1j * A_im
        Bc = B_re + 1j * B_im
        Cc = C_re + 1j * C_im
        logdA = dt * A
        dB = dt * Bc
        l = (lambda x, dt: x.to(dt))(torch.arange(L), A_re.dtype)
        P = torch.exp(logdA[:, :, None] * l[None, None, :])
        K = torch.einsum("dn,dnl,dn->dl", Cc, P, dB).real
        L2 = 2 * L
        Kp = _pad(K, ((0, 0), (0, L)))
        up = (lambda x, *d: x.permute(*d))(u, 0, 2, 1)
        up = _pad(up, ((0, 0), (0, 0), (0, L)))
        Kf = (lambda x, axes=(-2,-1): torch.fft.rfft2(x.float(), dim=axes))(Kp[:, None, :], axes=(-2, -1))
        Uf = (lambda x, axes=(-2,-1): torch.fft.rfft2(x.float(), dim=axes))(up[:, :, None, :], axes=(-2, -1))
        Yf = Uf * Kf[None, :, :, :]
        y = (lambda x, s, axes=(-2,-1): torch.fft.irfft2(x, s=s, dim=axes).to(torch.bfloat16))(Yf, (1, L2), axes=(-2, -1))[:, :, 0, :L]
        y = (lambda x, *d: x.permute(*d))(y, 0, 2, 1) + u * Dskip[None, None, :]
        return y

    def _B_ref(x, wqkv, wo):
        B, S, D = x.shape
        H = 32; Dh = D // H
        W, dil = 8, 2
        qkv = (lambda x, *d: x.permute(*d))((x @ wqkv).reshape(B, S, 3, H, Dh), 2, 0, 3, 1, 4)
        q, k, v = qkv[0], qkv[1], qkv[2]
        scale = Dh ** -0.5
        pos = torch.arange(S)
        off = torch.arange(W) * dil
        idx = pos[:, None] - off[None, :]
        mask = idx >= 0
        idx_c = torch.where(mask, idx, 0).reshape(-1)
        kg = k[:, :, idx_c, :].reshape(B, H, S, W, Dh)
        vg = v[:, :, idx_c, :].reshape(B, H, S, W, Dh)
        logits = torch.einsum("bhsd,bhswd->bhsw", q, kg) * scale
        logits = torch.where(mask[None, None, :, :], logits, -1e9)
        attn = _softmax(logits, axis=-1)
        o = torch.einsum("bhsw,bhswd->bhsd", attn, vg)
        return (lambda x, *d: x.permute(*d))(o, 0, 2, 1, 3).reshape(B, S, D) @ wo

    x = A_u
    x = x + _A_ref(_layernorm(x, axis=-1), A_A_re, A_A_im, A_B_re, A_B_im, A_C_re, A_C_im, A_log_dt, A_Dskip)
    x = x + _B_ref(_layernorm(x, axis=-1), B_wqkv, B_wo)
    x = x + _A_ref(_layernorm(x, axis=-1), A_A_re, A_A_im, A_B_re, A_B_im, A_C_re, A_C_im, A_log_dt, A_Dskip)
    x = x + _B_ref(_layernorm(x, axis=-1), B_wqkv, B_wo)
    return x
```

```asm
; @launch grid=(256,1,1) block=(256,1,1) lds=163840
.amdgcn_target "amdgcn-amd-amdhsa--gfx950"
.text
.globl interleave_layers__ssm_conv_s4__sliding_local_dilated__prompt_kernel
.p2align 8
.type interleave_layers__ssm_conv_s4__sliding_local_dilated__prompt_kernel,@function
interleave_layers__ssm_conv_s4__sliding_local_dilated__prompt_kernel:
    s_cmp_ge_u32 s2, 256
    s_cbranch_scc1 L_end
    s_load_dwordx16 s[36:51], s[0:1], 0
    s_load_dwordx8 s[52:59], s[0:1], 64
    s_load_dwordx4 s[60:63], s[0:1], 96
    s_load_dwordx2 s[64:65], s[0:1], 112
    s_getpc_b64 s[90:91]
L_pc:
    v_lshrrev_b32 v53, 6, v0
    v_and_b32 v1, 63, v0
    s_lshr_b32 s73, s2, 3
    v_readfirstlane_b32 s33, v53
    s_nop 0
    s_cmp_lg_u32 s33, 1
    s_cbranch_scc1 L_nc_1
    s_lshr_b32 s74, s2, 3
    s_lshl_b32 s74, s74, 11
    s_add_u32 s74, s90, s74
    s_addc_u32 s75, s91, 0
    v_lshlrev_b32 v49, 7, v1
    v_mov_b32 v51, s75
    v_add_co_u32 v50, vcc, s74, v49
    s_nop 1
    v_addc_co_u32 v51, vcc, 0, v51, vcc
    s_mov_b64 exec, 0xffff
    global_load_dword v254, v[50:51], off
    s_mov_b64 exec, -1
L_nc_1:
    v_lshlrev_b32 v48, 4, v0
    v_and_b32 v2, 15, v0
    v_bfe_u32 v3, v0, 4, 2
    s_and_b32 s66, s73, 7
    s_and_b32 s72, s2, 7
    s_lshl_b32 s34, s72, 5
    s_add_u32 s34, s34, s73
    s_lshl_b32 s35, s72, 2
    s_lshr_b32 s74, s2, 6
    s_add_u32 s35, s35, s74
    s_and_b32 s69, s33, 1
    s_lshr_b32 s70, s33, 1
    s_lshl_b32 s72, s2, 13
    s_lshl_b32 s73, s33, 11
    s_add_u32 s73, s73, s72
    v_lshl_add_u32 v55, v1, 4, s73
    s_lshr_b32 s72, s2, 2
    s_lshl_b32 s72, s72, 15
    s_and_b32 s73, s2, 3
    s_lshl_b32 s73, s73, 2
    s_add_u32 s77, s73, s33
    s_lshl_b32 s73, s77, 6
    s_add_u32 s72, s72, s73
    v_and_b32 v46, 7, v0
    v_and_b32 v47, 56, v0
    v_lshl_add_u32 v56, v46, 12, v47
    v_add_u32 v56, s72, v56
    s_lshl_b32 s75, s34, 9
    v_lshl_add_u32 v57, v0, 1, s75
    s_lshl_b32 s75, s34, 2
    v_lshlrev_b32 v253, 7, v1
    v_mov_b32 v60, 0
    v_mov_b32 v61, 0
    v_mov_b32 v62, 0
    v_mov_b32 v63, 0
    v_lshrrev_b32 v45, 2, v1
    v_lshlrev_b32 v45, 7, v45
    v_and_b32 v54, 3, v1
    v_lshl_add_u32 v45, v54, 4, v45
    v_mov_b32 v32, 0
    v_mov_b32 v33, 0
    v_mov_b32 v34, 0
    v_mov_b32 v35, 0
    v_mov_b32 v36, 0
    v_mov_b32 v37, 0
    s_mov_b32 s10, 268435456
    s_mov_b32 s11, 0x20000
    s_mov_b32 s18, 1572864
    s_mov_b32 s19, 0x20000
    s_mov_b32 s22, 524288
    s_mov_b32 s23, 0x20000
    s_mov_b32 s26, 2097152
    s_mov_b32 s27, 0x20000
    s_add_u32 s74, s90, L_table - L_pc
    s_addc_u32 s76, s91, 0
    v_mov_b32 v51, s76
    v_add_co_u32 v50, vcc, s74, v48
    s_lshl_b32 s72, s2, 2
    v_lshl_add_u32 v74, v1, 11, s72
    v_addc_co_u32 v51, vcc, 0, v51, vcc
    v_lshrrev_b32 v104, 1, v2
    v_mul_u32_u24 v104, 32896, v104
    v_and_b32 v105, 1, v2
    v_lshl_add_u32 v105, v105, 2, v3
    v_lshl_add_u32 v240, v105, 4, v104
    s_mul_i32 s4, s33, 263168
    s_lshl_b32 s72, s34, 7
    s_add_u32 s4, s4, s72
    s_add_u32 s4, s4, 1048576
    s_add_u32 s5, s4, 1052672
    v_lshlrev_b32 v104, 6, v2
    v_lshl_add_u32 v104, v3, 4, v104
    s_lshl_b32 s72, s33, 10
    v_add_u32 v241, s72, v104
    v_and_b32 v106, 1, v3
    v_lshrrev_b32 v107, 1, v3
    v_lshlrev_b32 v107, 4, v107
    v_lshlrev_b32 v104, 5, v2
    v_mul_u32_u24 v105, 4608, v106
    v_add3_u32 v105, v105, v104, v107
    s_lshl_b32 s72, s33, 9
    s_add_u32 s72, s72, 89600
    v_add_u32 v242, s72, v105
    s_mul_i32 s72, s70, 4608
    s_lshl_b32 s73, s69, 8
    s_sub_u32 s74, s72, s73
    s_add_u32 s74, s74, 89376
    v_lshl_add_u32 v105, v3, 4, v104
    v_add_u32 v243, s74, v105
    v_lshrrev_b32 v104, 2, v2
    v_and_b32 v105, 3, v2
    v_lshl_add_u32 v105, v105, 5, v107
    v_lshl_add_u32 v105, v106, 7, v105
    v_mul_u32_u24 v248, 65664, v104
    v_add_u32 v248, v248, v105
    s_mul_i32 s78, s33, 262656
    s_lshl_b32 s72, s34, 8
    s_add_u32 s78, s78, s72
    s_add_u32 s78, s78, 3407872
    s_add_u32 s79, s78, 1050624
    s_waitcnt lgkmcnt(0)
    global_load_dwordx2 v[24:25], v56, s[36:37] offset:0
    global_load_dwordx2 v[26:27], v56, s[36:37] offset:1024
    global_load_dwordx2 v[28:29], v56, s[36:37] offset:2048
    global_load_dwordx2 v[30:31], v56, s[36:37] offset:3072
    global_load_dwordx4 v[16:19], v55, s[36:37]
    global_load_dwordx4 v[20:23], v55, s[36:37] offset:1024
    s_load_dword s68, s[50:51], s75
    s_load_dword s67, s[52:53], s75
    global_load_short_d16_hi v32, v57, s[38:39]
    global_load_short_d16_hi v33, v57, s[40:41]
    global_load_short_d16_hi v34, v57, s[42:43]
    global_load_short_d16_hi v35, v57, s[44:45]
    global_load_short_d16_hi v36, v57, s[46:47]
    global_load_short_d16_hi v37, v57, s[48:49]
    global_load_dwordx4 v[40:43], v[50:51], off
    global_load_dword v44, v[50:51], off offset:16
    s_mov_b64 s[8:9], s[64:65]
    s_mov_b64 s[16:17], s[56:57]
    s_mov_b64 s[20:21], s[58:59]
    s_mov_b64 s[24:25], s[60:61]
    s_getreg_b32 s101, hwreg(HW_REG_XCC_ID, 0, 4)
    s_lshl_b32 s100, s35, 6
    s_add_u32 s100, s100, 180224
    s_cmp_lt_u32 s33, 2
    s_cbranch_scc1 L_ch01
    s_cmp_eq_u32 s33, 2
    s_cbranch_scc1 L_ch2
    s_lshl2_add_u32 s72, s66, s100
    v_mov_b32 v58, s101
    s_mov_b64 exec, 1
    buffer_store_dword v58, v253, s[8:11], s72 offen sc1
    s_mul_i32 s72, s2, 6144
    s_lshl_b32 s73, s2, 11
    s_mov_b64 exec, 0xffff
    buffer_load_dword v254, v253, s[20:23], s73 offen
    s_mov_b32 exec_lo, -1
    s_mov_b32 exec_hi, 0xffff
    buffer_load_dword v254, v253, s[16:19], s72 offen
    s_mov_b64 exec, -1
    s_branch L_chj
L_ch2:
    s_lshl_b32 s72, s2, 9
    s_add_u32 s72, s72, 32768
    s_min_u32 s72, s72, 146944
    s_mov_b64 exec, 0xffff
    buffer_store_dwordx4 v[60:63], v45, s[8:11], s72 offen sc1
    s_lshl_b32 s72, s2, 6
    s_add_u32 s72, s72, 163840
    s_mov_b64 exec, 0xf
    buffer_store_dwordx4 v[60:63], v45, s[8:11], s72 offen sc1
    s_mov_b64 exec, -1
    s_branch L_chj
L_ch01:
    s_cmp_eq_u32 s33, 1
    s_cbranch_scc1 L_ch1
    global_load_dword v73, v60, s[64:65] offset:1536 sc1
    s_mov_b64 exec, 0xff
    global_atomic_add v74, v60, s[64:65] sc1
    s_mov_b64 exec, -1
    v_lshrrev_b32 v58, 2, v1
    v_mul_u32_u24 v58, 4160, v58
    v_and_b32 v59, 3, v1
    v_lshl_add_u32 v58, v59, 4, v58
    v_add_u32 v58, 76544, v58
    s_mov_b64 exec, 0xffff
    ds_write_b128 v58, v[60:63]
    s_mov_b64 exec, -1
    s_mov_b64 exec, -1
    s_branch L_chj
L_ch1:
    v_and_b32 v58, 31, v1
    v_lshlrev_b32 v58, 4, v58
    v_lshrrev_b32 v59, 5, v1
    v_mul_u32_u24 v59, 4608, v59
    v_add_u32 v58, v58, v59
    v_add_u32 v58, 89088, v58
    ds_write_b128 v58, v[60:63]
    v_mov_b32 v58, 69632
    ds_write_b32 v58, v60
    ds_write_b32 v58, v60 offset:2048
L_chj:
    v_lshrrev_b32 v104, 3, v1
    v_and_b32 v105, 6, v104
    v_and_b32 v106, 7, v1
    v_xor_b32 v105, v105, v106
    v_lshlrev_b32 v105, 4, v105
    v_mul_u32_u24 v104, 3072, v104
    v_add_u32 v8, v104, v105
    v_add_u32 v9, 23552, v8
    v_add_u32 v10, 47104, v8
    v_add_u32 v11, 70656, v8
    s_mul_i32 s92, s33, 98304
    s_lshl_b32 s72, s66, 7
    s_add_u32 s92, s92, s72
    s_lshl_b32 s32, s33, 12
    s_add_u32 s88, s32, 98304
    v_lshlrev_b32 v252, 11, v1
    s_and_b32 s99, s2, 7
    s_lshl_b32 s99, s99, 11
    s_and_b32 s72, s2, 3
    s_and_b32 s73, s2, 4
    s_lshl1_add_u32 s72, s73, s72
    s_and_b32 s73, s2, 8
    s_lshr_b32 s73, s73, 1
    s_add_u32 s6, s72, s73
    s_lshl_b32 s98, s6, 7
    s_add_u32 s98, s98, 32768
    s_lshl_b32 s72, s33, 1
    s_lshl_b64 s[0:1], 3, s72
    s_lshl_b64 s[56:57], s[0:1], 8
    s_lshl_b32 s72, s33, 2
    s_lshl_b64 s[58:59], 15, s72
    v_and_b32 v58, 1, v3
    v_lshrrev_b32 v59, 1, v3
    v_lshlrev_b32 v58, 2, v58
    v_lshl_add_u32 v58, v59, 13, v58
    s_lshl_b32 s72, s2, 5
    s_lshl_b32 s73, s33, 3
    s_add_u32 s72, s72, s73
    s_add_u32 s93, s72, 147456
    s_mov_b32 exec_lo, 0x00010001
    s_mov_b32 exec_hi, 0x00010001
    buffer_store_dword v60, v58, s[8:11], s93 offen sc1
    s_mov_b64 exec, -1
    s_lshr_b32 s72, s2, 2
    s_mul_i32 s94, s72, 32896
    s_lshl_b32 s72, s77, 11
    s_add_u32 s94, s94, s72
    s_add_u32 s94, s94, 1048576
    v_lshlrev_b32 v47, 5, v47
    v_lshl_add_u32 v47, v46, 4, v47
    v_mul_u32_u24 v100, 544, v2
    v_lshl_add_u32 v100, v3, 4, v100
    s_mul_i32 s72, s70, 31008
    v_add_u32 v100, s72, v100
    s_mul_i32 s73, s69, 17408
    v_add_u32 v101, s73, v100
    s_lshl_b32 s73, s69, 8
    s_add_u32 s96, s72, s73
    s_lshl_b32 s72, s33, 10
    s_add_u32 s72, s72, 65536
    v_lshl_add_u32 v102, v1, 3, s72
    v_add_u32 v103, 72448, v48
    v_lshrrev_b32 v104, 1, v2
    v_lshlrev_b32 v105, 2, v3
    v_sub_u32 v104, v105, v104
    v_and_b32 v105, 1, v2
    v_xor_b32 v105, 1, v105
    v_mul_u32_u24 v105, 1040, v105
    v_add_u32 v104, v104, v105
    s_mul_i32 s72, s70, 8320
    s_lshl_b32 s73, s69, 8
    s_sub_u32 s72, s72, s73
    s_add_u32 s72, s72, 75804
    v_lshl_add_u32 v244, v104, 2, s72
    v_subrev_u32 v245, 1024, v244
    v_subrev_u32 v246, 2048, v244
    v_lshlrev_b32 v105, 1, v3
    v_sub_u32 v104, v104, v105
    s_mul_i32 s72, s70, 8320
    s_add_u32 s72, s72, s73
    s_add_u32 s72, s72, 72476
    v_lshl_add_u32 v247, v104, 2, s72
    s_lshl_b32 s72, s69, 10
    s_add_u32 s72, s72, 66304
    v_lshl_add_u32 v249, v1, 4, s72
    s_mul_i32 s72, s69, 4112
    s_add_u32 s72, s72, 0xfe0
    v_lshlrev_b32 v104, v2, s72
    v_lshlrev_b32 v105, 3, v3
    v_lshrrev_b32 v104, v105, v104
    s_mov_b32 s74, 0xffff
    v_bfe_i32 v105, v104, 0, 1
    v_bfe_i32 v106, v104, 1, 1
    v_bfi_b32 v105, s74, v105, v106
    v_and_b32 v52, 0x3f803f80, v105
    v_bfe_i32 v105, v104, 2, 1
    v_bfe_i32 v106, v104, 3, 1
    v_bfi_b32 v105, s74, v105, v106
    v_and_b32 v53, 0x3f803f80, v105
    v_bfe_i32 v105, v104, 4, 1
    v_bfe_i32 v106, v104, 5, 1
    v_bfi_b32 v105, s74, v105, v106
    v_and_b32 v54, 0x3f803f80, v105
    v_bfe_i32 v105, v104, 6, 1
    v_bfe_i32 v106, v104, 7, 1
    v_bfi_b32 v105, s74, v105, v106
    v_and_b32 v55, 0x3f803f80, v105
    s_mov_b32 s7, 147456
    s_lshl_b32 s72, s33, 12
    s_add_u32 s72, s72, s7
    v_lshl_add_u32 v250, v1, 4, s72
    s_lshl_b32 s72, s33, 10
    s_add_u32 s72, s72, s7
    v_lshl_add_u32 v251, v1, 4, s72
    v_bfe_u32 v104, v1, 3, 2
    v_xor_b32 v104, s33, v104
    v_lshlrev_b32 v104, 5, v104
    v_lshrrev_b32 v105, 2, v1
    v_lshl_add_u32 v104, v105, 7, v104
    v_and_b32 v105, 3, v1
    v_lshl_add_u32 v208, v105, 3, v104
    v_add_u32 v217, 98304, v208
    s_mov_b32 s82, 0x3b000000
    s_mov_b32 s83, 0x3b000000
    s_and_b32 s72, s35, 3
    s_lshl_b32 s72, s72, 1
    s_lshr_b32 s45, 0x24, s72
    s_and_b32 s45, s45, 3
    s_lshl_b32 s45, s45, 14
    s_lshr_b32 s46, 0x49, s72
    s_and_b32 s46, s46, 3
    s_lshl_b32 s46, s46, 14
    s_lshr_b32 s47, 0x92, s72
    s_and_b32 s47, s47, 3
    s_lshl_b32 s47, s47, 14
    v_mov_b32 v236, 0x3f803f80
    v_mov_b32 v237, 0x3f803f80
    v_mov_b32 v238, 0x3f803f80
    v_mov_b32 v239, 0x3f803f80
    v_lshrrev_b32 v104, 3, v1
    v_and_b32 v105, 6, v104
    v_and_b32 v106, 7, v1
    v_xor_b32 v105, v105, v106
    v_lshlrev_b32 v105, 4, v105
    v_mul_u32_u24 v104, 128, v104
    v_add_u32 v209, v104, v105
    s_cmp_eq_u32 s35, 0
    s_cselect_b32 s72, 0x40000000, 0
    v_lshlrev_b32 v211, 4, v1
    v_add_u32 v210, s72, v211
    s_lshl_b32 s72, s33, 5
    v_xor_b32 v204, s72, v208
    v_xor_b32 v205, 32, v204
    v_xor_b32 v206, 64, v204
    v_xor_b32 v207, 96, v204
    v_and_b32 v104, 3, v1
    v_lshrrev_b32 v105, 2, v2
    v_cmp_eq_u32 s[84:85], 1, v104
    v_cmp_eq_u32 s[12:13], 2, v104
    v_cmp_eq_u32 s[14:15], 3, v104
    v_cmp_eq_u32 s[28:29], v105, v3
    v_lshlrev_b32 v214, 2, v2
    v_add_u32 v214, 65536, v214
    v_lshlrev_b32 v215, 4, v3
    v_add_u32 v215, 65536, v215
    s_lshl_b32 s72, s33, 6
    v_add_u32 v216, s72, v214
    s_lshl_b32 s40, s33, 10
    s_mul_i32 s39, s35, 65664
    s_add_u32 s39, s39, 3407872
    s_add_u32 s37, s39, s32
    s_add_u32 s39, s39, s40
    s_lshl3_add_u32 s72, s35, s66
    s_lshl_b32 s72, s72, 12
    s_add_u32 s72, s72, s40
    s_add_u32 s38, s72, 17301504
    s_add_u32 s71, s38, 32768
    s_add_u32 s60, s35, 0
    s_and_b32 s60, s60, 3
    s_lshl_b32 s60, s60, 14
    s_add_u32 s61, s35, 1
    s_and_b32 s61, s61, 3
    s_lshl_b32 s61, s61, 14
    s_add_u32 s62, s35, 2
    s_and_b32 s62, s62, 3
    s_lshl_b32 s62, s62, 14
    s_add_u32 s63, s35, 3
    s_and_b32 s63, s63, 3
    s_lshl_b32 s63, s63, 14
    s_lshl_b32 s43, s35, 7
    s_add_u32 s43, s43, 131072
    s_cmp_eq_u32 s35, 0
    s_cselect_b64 s[76:77], -1, 0
    v_lshrrev_b32 v105, 1, v3
    v_lshlrev_b32 v105, 8, v105
    v_lshl_add_u32 v105, v2, 4, v105
    v_and_b32 v104, 1, v3
    v_mul_u32_u24 v104, 131584, v104
    v_add_u32 v212, v104, v105
    v_lshl_add_u32 v213, v104, 1, v212
    s_and_b32 s72, s35, 3
    s_mul_i32 s44, s72, 526336
    s_lshr_b32 s72, s35, 2
    s_lshl_b32 s72, s72, 12
    s_add_u32 s44, s44, s72
    s_add_u32 s44, s44, 1048576
    s_lshr_b32 s72, s66, 1
    s_mul_i32 s41, s72, 32896
    s_and_b32 s72, s66, 1
    s_lshl2_add_u32 s72, s72, s33
    s_lshl_b32 s72, s72, 9
    s_add_u32 s41, s41, s72
    s_add_u32 s41, s41, s44
    s_mul_i32 s72, s33, 131584
    s_add_u32 s44, s44, s72
    v_mov_b32 v104, 0xf149f2ca
    v_and_b32 v105, 1, v2
    v_cmp_eq_u32 s[86:87], 1, v105
    v_lshl_add_u32 v108, v3, 2, 0
    v_cmp_le_u32 s[90:91], v108, v2
    v_cndmask_b32 v106, 0, v104, s[86:87]
    v_cndmask_b32 v107, v104, 0, s[86:87]
    v_cndmask_b32 v220, v104, v106, s[90:91]
    v_cndmask_b32 v224, v106, v104, s[90:91]
    v_cndmask_b32 v228, v224, v104, s[76:77]
    v_lshl_add_u32 v108, v3, 2, 1
    v_cmp_le_u32 s[90:91], v108, v2
    v_lshl_add_u32 v108, v3, 2, 2
    v_lshl_add_u32 v105, v3, 2, v105
    v_cndmask_b32 v221, v104, v107, s[90:91]
    v_cndmask_b32 v225, v107, v104, s[90:91]
    v_cndmask_b32 v229, v225, v104, s[76:77]
    v_cmp_le_u32 s[90:91], v108, v2
    v_lshl_add_u32 v108, v3, 2, 3
    s_lshl_b32 s51, s35, 16
    v_cndmask_b32 v222, v104, v106, s[90:91]
    v_cndmask_b32 v226, v106, v104, s[90:91]
    v_cndmask_b32 v230, v226, v104, s[76:77]
    v_cmp_le_u32 s[90:91], v108, v2
    v_mov_b32 v108, 0x0c0c0c0c
    v_mov_b32 v106, 0xc0c0100
    v_cndmask_b32 v223, v104, v107, s[90:91]
    v_cndmask_b32 v227, v107, v104, s[90:91]
    v_cndmask_b32 v231, v227, v104, s[76:77]
    v_mov_b32 v107, 0x1000c0c
    v_cndmask_b32 v106, v106, v107, s[86:87]
    v_cmp_le_u32 s[90:91], v105, v2
    v_add_u32 v105, 2, v105
    v_mov_b32 v107, 0x3020c0c
    v_cndmask_b32 v234, v108, v106, s[90:91]
    v_cndmask_b32 v232, v106, v108, s[90:91]
    v_mov_b32 v106, 0xc0c0302
    v_cndmask_b32 v106, v106, v107, s[86:87]
    v_cmp_le_u32 s[90:91], v105, v2
    s_lshl_b32 s72, s33, 14
    s_add_u32 s51, s51, s72
    v_cndmask_b32 v235, v108, v106, s[90:91]
    v_cndmask_b32 v233, v106, v108, s[90:91]
    s_lshl_b32 s73, s66, 7
    s_add_u32 s51, s51, s73
    v_mov_b32 v4, -1
    v_mov_b32 v5, -1
    v_mov_b32 v6, -1
    v_mov_b32 v7, -1
    s_mov_b32 s72, 0x05040100
    s_mov_b32 s73, 0x07060302
    s_mov_b32 s74, 0x3f803f80
    v_mov_b32 v88, 0x3fb8aa3b
    s_waitcnt vmcnt(13)
    v_perm_b32 v80, v26, v24, s72
    v_perm_b32 v82, v26, v24, s73
    v_perm_b32 v84, v27, v25, s72
    v_perm_b32 v86, v27, v25, s73
    s_waitcnt vmcnt(11)
    v_perm_b32 v81, v30, v28, s72
    v_perm_b32 v83, v30, v28, s73
    buffer_store_dwordx4 v[80:83], v47, s[8:11], s94 offen offset:0 sc1
    v_perm_b32 v85, v31, v29, s72
    v_perm_b32 v87, v31, v29, s73
    buffer_store_dwordx4 v[84:87], v47, s[8:11], s94 offen offset:128 sc1
    s_waitcnt vmcnt(12)
    v_dot2_f32_bf16 v76, v16, s74, 0
    v_dot2_f32_bf16 v77, v16, v16, 0
    s_waitcnt vmcnt(11)
    v_dot2_f32_bf16 v78, v20, s74, 0
    v_dot2_f32_bf16 v79, v20, v20, 0
    v_dot2_f32_bf16 v76, v17, s74, v76
    v_dot2_f32_bf16 v77, v17, v17, v77
    v_dot2_f32_bf16 v78, v21, s74, v78
    v_dot2_f32_bf16 v79, v21, v21, v79
    v_dot2_f32_bf16 v76, v18, s74, v76
    v_dot2_f32_bf16 v77, v18, v18, v77
    v_dot2_f32_bf16 v78, v22, s74, v78
    v_dot2_f32_bf16 v79, v22, v22, v79
    v_dot2_f32_bf16 v76, v19, s74, v76
    v_dot2_f32_bf16 v77, v19, v19, v77
    v_dot2_f32_bf16 v78, v23, s74, v78
    v_dot2_f32_bf16 v79, v23, v23, v79
    s_lshl_b32 s76, s35, 1
    s_add_u32 s76, s76, s70
    s_mul_i32 s48, s76, 32896
    v_permlane32_swap_b32 v76, v77
    v_permlane32_swap_b32 v78, v79
    v_add_f32 v76, v76, v77
    v_add_f32 v78, v78, v79
    s_lshl_b32 s77, s66, 12
    s_add_u32 s48, s48, s77
    v_permlane16_swap_b32 v76, v78
    v_add_f32 v76, v76, v78
    s_lshl_b32 s77, s69, 6
    s_add_u32 s48, s48, s77
    v_add_f32_dpp v76, v76, v76 row_ror:8 row_mask:0xf bank_mask:0xf
    s_add_u32 s48, s48, 8650752
    s_lshl_b32 s76, s35, 2
    v_add_f32_dpp v76, v76, v76 row_ror:4 row_mask:0xf bank_mask:0xf
    s_add_u32 s76, s76, s33
    s_lshl_b32 s49, s76, 6
    v_add_f32_dpp v76, v76, v76 row_ror:2 row_mask:0xf bank_mask:0xf
    s_add_u32 s49, s49, 163840
    s_lshl_b32 s50, s66, 13
    v_add_f32_dpp v76, v76, v76 row_ror:1 row_mask:0xf bank_mask:0xf
    s_mov_b32 exec_lo, 0x00010001
    s_mov_b32 exec_hi, 0x00010001
    buffer_store_dword v76, v58, s[8:11], s93 offen sc1
    s_mov_b64 exec, -1
    s_lshl_b32 s75, s70, 4
    s_waitcnt lgkmcnt(0)
    s_lshr_b32 s76, s68, s75
    s_lshl_b32 s76, s76, 16
    s_lshl_b32 s30, s67, 16
    s_and_b32 s31, s67, 0xffff0000
    v_mul_f32 v89, s76, v88
    v_exp_f32 v89, v89
    s_nop 0
    v_cvt_pk_bf16_f32 v89, v89, v89
    v_lshlrev_b32 v89, 16, v89
    s_waitcnt vmcnt(11)
    v_mul_f32 v90, v89, v32
    s_waitcnt vmcnt(10)
    v_mul_f32 v91, v89, v33
    v_mul_f32 v90, v90, v88
    v_mul_f32 v91, 0.15915494, v91
    s_waitcnt vmcnt(9)
    v_mul_f32 v34, v89, v34
    s_waitcnt vmcnt(8)
    v_mul_f32 v35, v89, v35
    v_mul_f32 v184, 0x3f800000, v90
    v_mul_f32 v185, 0x3f800000, v91
    v_exp_f32 v184, v184
    v_fract_f32 v185, v185
    v_mul_f32 v186, 0x41000000, v90
    v_mul_f32 v187, 0xc1000000, v91
    v_exp_f32 v186, v186
    v_fract_f32 v187, v187
    v_mul_f32 v188, 0x43000000, v90
    v_mul_f32 v189, 0x43000000, v91
    v_exp_f32 v188, v188
    v_fract_f32 v189, v189
    s_waitcnt vmcnt(6)
    v_pk_mul_f32 v[190:191], v[36:37], v[34:35] op_sel:[0,0] op_sel_hi:[1,0]
    v_pk_fma_f32 v[104:105], v[36:37], v[34:35], v[190:191] op_sel:[1,1,0] op_sel_hi:[0,1,1] neg_lo:[1,0,0]
    v_cos_f32 v92, v185
    v_sin_f32 v93, v185
    v_cos_f32 v94, v187
    v_sin_f32 v95, v187
    v_cos_f32 v96, v189
    v_sin_f32 v97, v189
    s_mov_b32 m0, s96
    v_pk_mul_f32 v[92:93], v[92:93], v[184:185] op_sel:[0,0] op_sel_hi:[1,0]
    s_nop 0
    v_pk_mul_f32 v[94:95], v[94:95], v[186:187] op_sel:[0,0] op_sel_hi:[1,0]
    v_pk_mul_f32 v[96:97], v[96:97], v[188:189] op_sel:[0,0] op_sel_hi:[1,0]
    v_mov_b32 v199, 0x3f80
    ds_write_addtid_b32 v199
    s_nop 0
    v_pk_mul_f32 v[190:191], v[104:105], v[92:93] op_sel:[0,0] op_sel_hi:[1,0]
    v_pk_fma_f32 v[108:109], v[104:105], v[92:93], v[190:191] op_sel:[1,1,0] op_sel_hi:[0,1,1] neg_lo:[1,0,0]
    v_cvt_pk_bf16_f32 v192, v104, v105
    s_mul_i32 s89, s60, 24
    s_add_u32 m0, s60, s88
    s_add_u32 s89, s89, s92
    s_mov_b32 s97, m0
    buffer_load_dwordx4 v8, s[16:19], s89 offen offset:0 lds
    s_mov_b32 m0, s96
    s_nop 0
    v_pk_mul_f32 v[190:191], v[108:109], v[92:93] op_sel:[0,0] op_sel_hi:[1,0]
    v_pk_fma_f32 v[110:111], v[108:109], v[92:93], v[190:191] op_sel:[1,1,0] op_sel_hi:[0,1,1] neg_lo:[1,0,0]
    ds_write_addtid_b32 v192 offset:8704
    v_cvt_pk_bf16_f32 v193, v94, v95
    v_pk_mul_f32 v[190:191], v[110:111], v[92:93] op_sel:[0,0] op_sel_hi:[1,0]
    v_pk_fma_f32 v[112:113], v[110:111], v[92:93], v[190:191] op_sel:[1,1,0] op_sel_hi:[0,1,1] neg_lo:[1,0,0]
    ds_write_addtid_b32 v193 offset:544
    v_cvt_pk_bf16_f32 v194, v108, v109
    v_pk_mul_f32 v[190:191], v[112:113], v[92:93] op_sel:[0,0] op_sel_hi:[1,0]
    v_pk_fma_f32 v[114:115], v[112:113], v[92:93], v[190:191] op_sel:[1,1,0] op_sel_hi:[0,1,1] neg_lo:[1,0,0]
    ds_write_addtid_b32 v194 offset:9248
    v_cvt_pk_bf16_f32 v195, v110, v111
    v_pk_mul_f32 v[190:191], v[114:115], v[92:93] op_sel:[0,0] op_sel_hi:[1,0]
    v_pk_fma_f32 v[116:117], v[114:115], v[92:93], v[190:191] op_sel:[1,1,0] op_sel_hi:[0,1,1] neg_lo:[1,0,0]
    ds_write_addtid_b32 v195 offset:9792
    v_cvt_pk_bf16_f32 v196, v112, v113
    v_pk_mul_f32 v[190:191], v[116:117], v[92:93] op_sel:[0,0] op_sel_hi:[1,0]
    v_pk_fma_f32 v[118:119], v[116:117], v[92:93], v[190:191] op_sel:[1,1,0] op_sel_hi:[0,1,1] neg_lo:[1,0,0]
    ds_write_addtid_b32 v196 offset:10336
    v_cvt_pk_bf16_f32 v197, v114, v115
    s_mov_b32 m0, s97
    s_nop 0
    buffer_load_dwordx4 v9, s[16:19], s89 offen offset:1024 lds
    s_mov_b32 m0, s96
    s_nop 0
    v_pk_mul_f32 v[190:191], v[118:119], v[92:93] op_sel:[0,0] op_sel_hi:[1,0]
    v_pk_fma_f32 v[120:121], v[118:119], v[92:93], v[190:191] op_sel:[1,1,0] op_sel_hi:[0,1,1] neg_lo:[1,0,0]
    ds_write_addtid_b32 v197 offset:10880
    v_cvt_pk_bf16_f32 v192, v116, v117
    v_pk_mul_f32 v[190:191], v[104:105], v[96:97] op_sel:[0,0] op_sel_hi:[1,0]
    v_pk_fma_f32 v[122:123], v[104:105], v[96:97], v[190:191] op_sel:[1,1,0] op_sel_hi:[0,1,1] neg_lo:[1,0,0]
    ds_write_addtid_b32 v192 offset:11424
    v_cvt_pk_bf16_f32 v193, v118, v119
    v_pk_mul_f32 v[190:191], v[108:109], v[96:97] op_sel:[0,0] op_sel_hi:[1,0]
    v_pk_fma_f32 v[124:125], v[108:109], v[96:97], v[190:191] op_sel:[1,1,0] op_sel_hi:[0,1,1] neg_lo:[1,0,0]
    ds_write_addtid_b32 v193 offset:11968
    v_cvt_pk_bf16_f32 v194, v120, v121
    s_mov_b32 m0, s97
    s_nop 0
    buffer_load_dwordx4 v10, s[16:19], s89 offen offset:2048 lds
    s_mov_b32 m0, s96
    s_nop 0
    v_pk_mul_f32 v[190:191], v[110:111], v[96:97] op_sel:[0,0] op_sel_hi:[1,0]
    v_pk_fma_f32 v[126:127], v[110:111], v[96:97], v[190:191] op_sel:[1,1,0] op_sel_hi:[0,1,1] neg_lo:[1,0,0]
    ds_write_addtid_b32 v194 offset:12512
    v_cvt_pk_bf16_f32 v195, v122, v123
    v_pk_mul_f32 v[190:191], v[112:113], v[96:97] op_sel:[0,0] op_sel_hi:[1,0]
    v_pk_fma_f32 v[128:129], v[112:113], v[96:97], v[190:191] op_sel:[1,1,0] op_sel_hi:[0,1,1] neg_lo:[1,0,0]
    ds_write_addtid_b32 v195 offset:13056
    v_cvt_pk_bf16_f32 v196, v124, v125
    v_pk_mul_f32 v[190:191], v[114:115], v[96:97] op_sel:[0,0] op_sel_hi:[1,0]
    v_pk_fma_f32 v[130:131], v[114:115], v[96:97], v[190:191] op_sel:[1,1,0] op_sel_hi:[0,1,1] neg_lo:[1,0,0]
    ds_write_addtid_b32 v196 offset:13600
    v_cvt_pk_bf16_f32 v197, v126, v127
    v_pk_mul_f32 v[190:191], v[116:117], v[96:97] op_sel:[0,0] op_sel_hi:[1,0]
    v_pk_fma_f32 v[132:133], v[116:117], v[96:97], v[190:191] op_sel:[1,1,0] op_sel_hi:[0,1,1] neg_lo:[1,0,0]
    ds_write_addtid_b32 v197 offset:14144
    v_cvt_pk_bf16_f32 v192, v128, v129
    s_mov_b32 m0, s97
    s_nop 0
    buffer_load_dwordx4 v11, s[16:19], s89 offen offset:3072 lds
    s_mov_b32 m0, s96
    s_nop 0
    v_pk_mul_f32 v[190:191], v[118:119], v[96:97] op_sel:[0,0] op_sel_hi:[1,0]
    v_pk_fma_f32 v[134:135], v[118:119], v[96:97], v[190:191] op_sel:[1,1,0] op_sel_hi:[0,1,1] neg_lo:[1,0,0]
    ds_write_addtid_b32 v192 offset:14688
    v_cvt_pk_bf16_f32 v193, v130, v131
    v_pk_mul_f32 v[190:191], v[120:121], v[96:97] op_sel:[0,0] op_sel_hi:[1,0]
    v_pk_fma_f32 v[136:137], v[120:121], v[96:97], v[190:191] op_sel:[1,1,0] op_sel_hi:[0,1,1] neg_lo:[1,0,0]
    ds_write_addtid_b32 v193 offset:15232
    v_cvt_pk_bf16_f32 v194, v132, v133
    v_pk_mul_f32 v[190:191], v[122:123], v[96:97] op_sel:[0,0] op_sel_hi:[1,0]
    v_pk_fma_f32 v[138:139], v[122:123], v[96:97], v[190:191] op_sel:[1,1,0] op_sel_hi:[0,1,1] neg_lo:[1,0,0]
    ds_write_addtid_b32 v194 offset:15776
    v_cvt_pk_bf16_f32 v195, v134, v135
    v_pk_mul_f32 v[190:191], v[126:127], v[96:97] op_sel:[0,0] op_sel_hi:[1,0]
    v_pk_fma_f32 v[140:141], v[126:127], v[96:97], v[190:191] op_sel:[1,1,0] op_sel_hi:[0,1,1] neg_lo:[1,0,0]
    ds_write_addtid_b32 v195 offset:16320
    v_cvt_pk_bf16_f32 v196, v136, v137
    v_pk_mul_f32 v[190:191], v[130:131], v[96:97] op_sel:[0,0] op_sel_hi:[1,0]
    v_pk_fma_f32 v[142:143], v[130:131], v[96:97], v[190:191] op_sel:[1,1,0] op_sel_hi:[0,1,1] neg_lo:[1,0,0]
    ds_write_addtid_b32 v196 offset:16864
    v_cvt_pk_bf16_f32 v197, v138, v139
    s_mov_b64 exec, 0
    s_cmp_eq_u32 s33, 0
    s_cbranch_scc1 L_warm_0_0
    s_cmp_eq_u32 s33, 1
    s_cbranch_scc1 L_warm_0_1
    s_cmp_eq_u32 s33, 2
    s_cbranch_scc1 L_warm_0_2
    s_branch L_wret_0
L_wret_0:
    s_mov_b64 exec, -1
    s_waitcnt vmcnt(4)
    s_barrier
    s_cmp_lg_u32 s33, 0
    s_cbranch_scc1 L_skip_2
    v_readfirstlane_b32 s95, v73
    s_nop 0
    s_mul_i32 s95, s95, 0x9E3779B5
    s_add_u32 s95, s95, 0x7F4A7C15
    v_mov_b32 v98, s95
    s_mov_b64 exec, 0xff
    global_store_dword v74, v98, s[64:65] sc1
    s_mov_b64 exec, -1
L_skip_2:
    s_mul_i32 s89, s61, 24
    s_add_u32 m0, s61, s88
    s_add_u32 s89, s89, s92
    s_mov_b32 s97, m0
    buffer_load_dwordx4 v8, s[16:19], s89 offen offset:0 lds
    s_mov_b32 m0, s96
    v_pk_mul_f32 v[190:191], v[134:135], v[96:97] op_sel:[0,0] op_sel_hi:[1,0]
    v_pk_fma_f32 v[144:145], v[134:135], v[96:97], v[190:191] op_sel:[1,1,0] op_sel_hi:[0,1,1] neg_lo:[1,0,0]
    ds_write_addtid_b32 v197 offset:17408
    v_cvt_pk_bf16_f32 v192, v140, v141
    v_pk_mul_f32 v[190:191], v[138:139], v[96:97] op_sel:[0,0] op_sel_hi:[1,0]
    v_pk_fma_f32 v[146:147], v[138:139], v[96:97], v[190:191] op_sel:[1,1,0] op_sel_hi:[0,1,1] neg_lo:[1,0,0]
    ds_write_addtid_b32 v192 offset:17952
    v_cvt_pk_bf16_f32 v193, v142, v143
    v_pk_mul_f32 v[190:191], v[140:141], v[96:97] op_sel:[0,0] op_sel_hi:[1,0]
    v_pk_fma_f32 v[148:149], v[140:141], v[96:97], v[190:191] op_sel:[1,1,0] op_sel_hi:[0,1,1] neg_lo:[1,0,0]
    ds_write_addtid_b32 v193 offset:18496
    v_cvt_pk_bf16_f32 v194, v144, v145
    s_mov_b32 m0, s97
    s_nop 0
    buffer_load_dwordx4 v9, s[16:19], s89 offen offset:1024 lds
    s_mov_b32 m0, s96
    s_nop 0
    v_pk_mul_f32 v[190:191], v[142:143], v[96:97] op_sel:[0,0] op_sel_hi:[1,0]
    v_pk_fma_f32 v[150:151], v[142:143], v[96:97], v[190:191] op_sel:[1,1,0] op_sel_hi:[0,1,1] neg_lo:[1,0,0]
    ds_write_addtid_b32 v194 offset:19040
    v_cvt_pk_bf16_f32 v195, v146, v147
    v_pk_mul_f32 v[190:191], v[144:145], v[96:97] op_sel:[0,0] op_sel_hi:[1,0]
    v_pk_fma_f32 v[152:153], v[144:145], v[96:97], v[190:191] op_sel:[1,1,0] op_sel_hi:[0,1,1] neg_lo:[1,0,0]
    ds_write_addtid_b32 v195 offset:19584
    v_cvt_pk_bf16_f32 v196, v148, v149
    v_pk_mul_f32 v[190:191], v[146:147], v[96:97] op_sel:[0,0] op_sel_hi:[1,0]
    v_pk_fma_f32 v[154:155], v[146:147], v[96:97], v[190:191] op_sel:[1,1,0] op_sel_hi:[0,1,1] neg_lo:[1,0,0]
    ds_write_addtid_b32 v196 offset:20128
    v_cvt_pk_bf16_f32 v197, v150, v151
    v_pk_mul_f32 v[190:191], v[150:151], v[96:97] op_sel:[0,0] op_sel_hi:[1,0]
    v_pk_fma_f32 v[156:157], v[150:151], v[96:97], v[190:191] op_sel:[1,1,0] op_sel_hi:[0,1,1] neg_lo:[1,0,0]
    ds_write_addtid_b32 v197 offset:20672
    v_cvt_pk_bf16_f32 v192, v152, v153
    s_mov_b32 m0, s97
    s_nop 0
    buffer_load_dwordx4 v10, s[16:19], s89 offen offset:2048 lds
    s_mov_b32 m0, s96
    s_nop 0
    v_pk_mul_f32 v[190:191], v[154:155], v[96:97] op_sel:[0,0] op_sel_hi:[1,0]
    v_pk_fma_f32 v[158:159], v[154:155], v[96:97], v[190:191] op_sel:[1,1,0] op_sel_hi:[0,1,1] neg_lo:[1,0,0]
    ds_write_addtid_b32 v192 offset:21216
    v_cvt_pk_bf16_f32 v193, v154, v155
    v_pk_mul_f32 v[190:191], v[156:157], v[96:97] op_sel:[0,0] op_sel_hi:[1,0]
    v_pk_fma_f32 v[160:161], v[156:157], v[96:97], v[190:191] op_sel:[1,1,0] op_sel_hi:[0,1,1] neg_lo:[1,0,0]
    ds_write_addtid_b32 v193 offset:21760
    v_cvt_pk_bf16_f32 v194, v156, v157
    v_pk_mul_f32 v[190:191], v[158:159], v[96:97] op_sel:[0,0] op_sel_hi:[1,0]
    v_pk_fma_f32 v[162:163], v[158:159], v[96:97], v[190:191] op_sel:[1,1,0] op_sel_hi:[0,1,1] neg_lo:[1,0,0]
    ds_write_addtid_b32 v194 offset:22304
    v_cvt_pk_bf16_f32 v195, v158, v159
    v_pk_mul_f32 v[190:191], v[160:161], v[96:97] op_sel:[0,0] op_sel_hi:[1,0]
    v_pk_fma_f32 v[164:165], v[160:161], v[96:97], v[190:191] op_sel:[1,1,0] op_sel_hi:[0,1,1] neg_lo:[1,0,0]
    ds_write_addtid_b32 v195 offset:22848
    v_cvt_pk_bf16_f32 v196, v160, v161
    v_pk_mul_f32 v[190:191], v[162:163], v[96:97] op_sel:[0,0] op_sel_hi:[1,0]
    v_pk_fma_f32 v[166:167], v[162:163], v[96:97], v[190:191] op_sel:[1,1,0] op_sel_hi:[0,1,1] neg_lo:[1,0,0]
    ds_write_addtid_b32 v196 offset:23392
    v_cvt_pk_bf16_f32 v197, v162, v163
    s_mov_b32 m0, s97
    s_nop 0
    buffer_load_dwordx4 v11, s[16:19], s89 offen offset:3072 lds
    s_mov_b32 m0, s96
    s_nop 0
    v_pk_mul_f32 v[190:191], v[164:165], v[96:97] op_sel:[0,0] op_sel_hi:[1,0]
    v_pk_fma_f32 v[168:169], v[164:165], v[96:97], v[190:191] op_sel:[1,1,0] op_sel_hi:[0,1,1] neg_lo:[1,0,0]
    ds_write_addtid_b32 v197 offset:23936
    v_cvt_pk_bf16_f32 v192, v164, v165
    v_pk_mul_f32 v[190:191], v[166:167], v[96:97] op_sel:[0,0] op_sel_hi:[1,0]
    v_pk_fma_f32 v[170:171], v[166:167], v[96:97], v[190:191] op_sel:[1,1,0] op_sel_hi:[0,1,1] neg_lo:[1,0,0]
    ds_write_addtid_b32 v192 offset:24480
    v_cvt_pk_bf16_f32 v193, v166, v167
    v_pk_mul_f32 v[190:191], v[170:171], v[96:97] op_sel:[0,0] op_sel_hi:[1,0]
    v_pk_fma_f32 v[172:173], v[170:171], v[96:97], v[190:191] op_sel:[1,1,0] op_sel_hi:[0,1,1] neg_lo:[1,0,0]
    ds_write_addtid_b32 v193 offset:25024
    v_cvt_pk_bf16_f32 v194, v168, v169
    s_mul_i32 s89, s62, 24
    s_add_u32 m0, s62, s88
    s_add_u32 s89, s89, s92
    s_mov_b32 s97, m0
    buffer_load_dwordx4 v8, s[16:19], s89 offen offset:0 lds
    s_mov_b32 m0, s96
    s_nop 0
    v_pk_mul_f32 v[190:191], v[172:173], v[96:97] op_sel:[0,0] op_sel_hi:[1,0]
    v_pk_fma_f32 v[174:175], v[172:173], v[96:97], v[190:191] op_sel:[1,1,0] op_sel_hi:[0,1,1] neg_lo:[1,0,0]
    ds_write_addtid_b32 v194 offset:25568
    v_cvt_pk_bf16_f32 v195, v170, v171
    v_pk_mul_f32 v[190:191], v[174:175], v[96:97] op_sel:[0,0] op_sel_hi:[1,0]
    v_pk_fma_f32 v[176:177], v[174:175], v[96:97], v[190:191] op_sel:[1,1,0] op_sel_hi:[0,1,1] neg_lo:[1,0,0]
    ds_write_addtid_b32 v195 offset:26112
    v_cvt_pk_bf16_f32 v196, v172, v173
    v_pk_mul_f32 v[190:191], v[176:177], v[96:97] op_sel:[0,0] op_sel_hi:[1,0]
    v_pk_fma_f32 v[178:179], v[176:177], v[96:97], v[190:191] op_sel:[1,1,0] op_sel_hi:[0,1,1] neg_lo:[1,0,0]
    ds_write_addtid_b32 v196 offset:26656
    v_cvt_pk_bf16_f32 v197, v174, v175
    v_pk_mul_f32 v[190:191], v[178:179], v[96:97] op_sel:[0,0] op_sel_hi:[1,0]
    v_pk_fma_f32 v[180:181], v[178:179], v[96:97], v[190:191] op_sel:[1,1,0] op_sel_hi:[0,1,1] neg_lo:[1,0,0]
    ds_write_addtid_b32 v197 offset:27200
    v_cvt_pk_bf16_f32 v192, v176, v177
    s_mov_b32 m0, s97
    s_nop 0
    buffer_load_dwordx4 v9, s[16:19], s89 offen offset:1024 lds
    s_mov_b32 m0, s96
    s_nop 0
    v_pk_mul_f32 v[190:191], v[180:181], v[96:97] op_sel:[0,0] op_sel_hi:[1,0]
    v_pk_fma_f32 v[182:183], v[180:181], v[96:97], v[190:191] op_sel:[1,1,0] op_sel_hi:[0,1,1] neg_lo:[1,0,0]
    ds_write_addtid_b32 v192 offset:27744
    v_cvt_pk_bf16_f32 v193, v178, v179
    v_pk_mul_f32 v[190:191], v[182:183], v[96:97] op_sel:[0,0] op_sel_hi:[1,0]
    v_pk_fma_f32 v[104:105], v[182:183], v[96:97], v[190:191] op_sel:[1,1,0] op_sel_hi:[0,1,1] neg_lo:[1,0,0]
    ds_write_addtid_b32 v193 offset:28288
    v_cvt_pk_bf16_f32 v194, v180, v181
    v_pk_mul_f32 v[190:191], v[104:105], v[96:97] op_sel:[0,0] op_sel_hi:[1,0]
    v_pk_fma_f32 v[106:107], v[104:105], v[96:97], v[190:191] op_sel:[1,1,0] op_sel_hi:[0,1,1] neg_lo:[1,0,0]
    ds_write_addtid_b32 v194 offset:28832
    v_cvt_pk_bf16_f32 v195, v182, v183
    v_pk_mul_f32 v[190:191], v[94:95], v[94:95] op_sel:[0,0] op_sel_hi:[1,0]
    v_pk_fma_f32 v[108:109], v[94:95], v[94:95], v[190:191] op_sel:[1,1,0] op_sel_hi:[0,1,1] neg_lo:[1,0,0]
    ds_write_addtid_b32 v195 offset:29376
    v_cvt_pk_bf16_f32 v196, v104, v105
    v_pk_mul_f32 v[190:191], v[108:109], v[94:95] op_sel:[0,0] op_sel_hi:[1,0]
    v_pk_fma_f32 v[110:111], v[108:109], v[94:95], v[190:191] op_sel:[1,1,0] op_sel_hi:[0,1,1] neg_lo:[1,0,0]
    ds_write_addtid_b32 v196 offset:29920
    v_cvt_pk_bf16_f32 v197, v106, v107
    s_mov_b32 m0, s97
    s_nop 0
    buffer_load_dwordx4 v10, s[16:19], s89 offen offset:2048 lds
    s_mov_b32 m0, s96
    s_nop 0
    v_pk_mul_f32 v[190:191], v[110:111], v[94:95] op_sel:[0,0] op_sel_hi:[1,0]
    v_pk_fma_f32 v[112:113], v[110:111], v[94:95], v[190:191] op_sel:[1,1,0] op_sel_hi:[0,1,1] neg_lo:[1,0,0]
    ds_write_addtid_b32 v197 offset:30464
    v_cvt_pk_bf16_f32 v192, v108, v109
    v_pk_mul_f32 v[190:191], v[112:113], v[94:95] op_sel:[0,0] op_sel_hi:[1,0]
    v_pk_fma_f32 v[114:115], v[112:113], v[94:95], v[190:191] op_sel:[1,1,0] op_sel_hi:[0,1,1] neg_lo:[1,0,0]
    ds_write_addtid_b32 v192 offset:1088
    v_cvt_pk_bf16_f32 v193, v110, v111
    v_pk_mul_f32 v[190:191], v[114:115], v[94:95] op_sel:[0,0] op_sel_hi:[1,0]
    v_pk_fma_f32 v[116:117], v[114:115], v[94:95], v[190:191] op_sel:[1,1,0] op_sel_hi:[0,1,1] neg_lo:[1,0,0]
    ds_write_addtid_b32 v193 offset:1632
    v_cvt_pk_bf16_f32 v194, v112, v113
    s_mov_b32 m0, s97
    s_nop 0
    buffer_load_dwordx4 v11, s[16:19], s89 offen offset:3072 lds
    s_mov_b32 m0, s96
    s_nop 0
    v_pk_mul_f32 v[190:191], v[116:117], v[94:95] op_sel:[0,0] op_sel_hi:[1,0]
    v_pk_fma_f32 v[118:119], v[116:117], v[94:95], v[190:191] op_sel:[1,1,0] op_sel_hi:[0,1,1] neg_lo:[1,0,0]
    ds_write_addtid_b32 v194 offset:2176
    v_cvt_pk_bf16_f32 v195, v114, v115
    v_pk_mul_f32 v[190:191], v[118:119], v[94:95] op_sel:[0,0] op_sel_hi:[1,0]
    v_pk_fma_f32 v[120:121], v[118:119], v[94:95], v[190:191] op_sel:[1,1,0] op_sel_hi:[0,1,1] neg_lo:[1,0,0]
    ds_write_addtid_b32 v195 offset:2720
    v_cvt_pk_bf16_f32 v196, v116, v117
    v_pk_mul_f32 v[190:191], v[120:121], v[94:95] op_sel:[0,0] op_sel_hi:[1,0]
    v_pk_fma_f32 v[122:123], v[120:121], v[94:95], v[190:191] op_sel:[1,1,0] op_sel_hi:[0,1,1] neg_lo:[1,0,0]
    ds_write_addtid_b32 v196 offset:3264
    v_cvt_pk_bf16_f32 v197, v118, v119
    v_pk_mul_f32 v[190:191], v[122:123], v[94:95] op_sel:[0,0] op_sel_hi:[1,0]
    v_pk_fma_f32 v[124:125], v[122:123], v[94:95], v[190:191] op_sel:[1,1,0] op_sel_hi:[0,1,1] neg_lo:[1,0,0]
    ds_write_addtid_b32 v197 offset:3808
    v_cvt_pk_bf16_f32 v192, v120, v121
    s_mul_i32 s89, s63, 24
    s_add_u32 m0, s63, s88
    s_add_u32 s89, s89, s92
    s_mov_b32 s97, m0
    buffer_load_dwordx4 v8, s[16:19], s89 offen offset:0 lds
    s_mov_b32 m0, s96
    s_nop 0
    v_pk_mul_f32 v[190:191], v[124:125], v[94:95] op_sel:[0,0] op_sel_hi:[1,0]
    v_pk_fma_f32 v[126:127], v[124:125], v[94:95], v[190:191] op_sel:[1,1,0] op_sel_hi:[0,1,1] neg_lo:[1,0,0]
    ds_write_addtid_b32 v192 offset:4352
    v_cvt_pk_bf16_f32 v193, v122, v123
    v_pk_mul_f32 v[190:191], v[126:127], v[94:95] op_sel:[0,0] op_sel_hi:[1,0]
    v_pk_fma_f32 v[128:129], v[126:127], v[94:95], v[190:191] op_sel:[1,1,0] op_sel_hi:[0,1,1] neg_lo:[1,0,0]
    ds_write_addtid_b32 v193 offset:4896
    v_cvt_pk_bf16_f32 v194, v124, v125
    v_pk_mul_f32 v[190:191], v[128:129], v[94:95] op_sel:[0,0] op_sel_hi:[1,0]
    v_pk_fma_f32 v[130:131], v[128:129], v[94:95], v[190:191] op_sel:[1,1,0] op_sel_hi:[0,1,1] neg_lo:[1,0,0]
    ds_write_addtid_b32 v194 offset:5440
    v_cvt_pk_bf16_f32 v195, v126, v127
    v_pk_mul_f32 v[190:191], v[130:131], v[94:95] op_sel:[0,0] op_sel_hi:[1,0]
    v_pk_fma_f32 v[132:133], v[130:131], v[94:95], v[190:191] op_sel:[1,1,0] op_sel_hi:[0,1,1] neg_lo:[1,0,0]
    ds_write_addtid_b32 v195 offset:5984
    v_cvt_pk_bf16_f32 v196, v128, v129
    v_pk_mul_f32 v[190:191], v[132:133], v[94:95] op_sel:[0,0] op_sel_hi:[1,0]
    v_pk_fma_f32 v[134:135], v[132:133], v[94:95], v[190:191] op_sel:[1,1,0] op_sel_hi:[0,1,1] neg_lo:[1,0,0]
    ds_write_addtid_b32 v196 offset:6528
    v_cvt_pk_bf16_f32 v197, v130, v131
    ds_write_addtid_b32 v197 offset:7072
    v_cvt_pk_bf16_f32 v192, v132, v133
    ds_write_addtid_b32 v192 offset:7616
    v_cvt_pk_bf16_f32 v193, v134, v135
    ds_write_addtid_b32 v193 offset:8160
    v_and_b32 v64, 0xffff, v40
    v_lshrrev_b32 v65, 16, v40
    v_and_b32 v66, 0xffff, v41
    v_lshrrev_b32 v67, 16, v41
    v_and_b32 v68, 0xffff, v42
    v_lshrrev_b32 v69, 16, v42
    v_and_b32 v70, 0xffff, v43
    v_lshrrev_b32 v71, 16, v43
    v_and_b32 v72, 0xffff, v44
    s_waitcnt lgkmcnt(0)
    s_barrier
    ds_read_b128 v[104:107], v100 offset:0
    ds_read_b128 v[108:111], v101 offset:8704
    ds_read_b128 v[112:115], v101 offset:17408
    s_mov_b32 m0, s97
    s_nop 0
    buffer_load_dwordx4 v9, s[16:19], s89 offen offset:1024 lds
    ds_read_b128 v[116:119], v100 offset:64
    ds_read_b128 v[120:123], v101 offset:8768
    ds_read_b128 v[124:127], v101 offset:17472
    buffer_load_dwordx4 v10, s[16:19], s89 offen offset:2048 lds
    ds_read_b128 v[128:131], v100 offset:128
    ds_read_b128 v[132:135], v101 offset:8832
    ds_read_b128 v[136:139], v101 offset:17536
    buffer_load_dwordx4 v11, s[16:19], s89 offen offset:3072 lds
    ds_read_b128 v[140:143], v100 offset:192
    ds_read_b128 v[144:147], v101 offset:8896
    ds_read_b128 v[148:151], v101 offset:17600
    s_waitcnt lgkmcnt(10)
    v_mfma_f32_16x16x32_bf16 v[92:95], v[108:111], v[104:107], 0
    s_waitcnt lgkmcnt(9)
    v_mfma_f32_16x16x32_bf16 v[96:99], v[112:115], v[104:107], 0
    ds_read_b128 v[152:155], v100 offset:256
    ds_read_b128 v[156:159], v101 offset:8960
    ds_read_b128 v[160:163], v101 offset:17664
    s_waitcnt lgkmcnt(9)
    v_mfma_f32_16x16x32_bf16 v[92:95], v[120:123], v[116:119], v[92:95]
    v_mfma_f32_16x16x32_bf16 v[96:99], v[124:127], v[116:119], v[96:99]
    ds_read_b128 v[164:167], v100 offset:320
    ds_read_b128 v[168:171], v101 offset:9024
    ds_read_b128 v[172:175], v101 offset:17728
    s_waitcnt lgkmcnt(6)
    v_mfma_f32_16x16x32_bf16 v[92:95], v[132:135], v[128:131], v[92:95]
    v_mfma_f32_16x16x32_bf16 v[96:99], v[136:139], v[128:131], v[96:99]
    ds_read_b128 v[176:179], v100 offset:384
    ds_read_b128 v[180:183], v101 offset:9088
    ds_read_b128 v[184:187], v101 offset:17792
    s_cmp_lg_u32 s33, 0
    s_cbranch_scc1 L_skip_3
    buffer_load_dwordx4 v[200:203], v48, s[8:11], s99 offen sc1
L_skip_3:
    v_mfma_f32_16x16x32_bf16 v[92:95], v[144:147], v[140:143], v[92:95]
    v_mfma_f32_16x16x32_bf16 v[96:99], v[148:151], v[140:143], v[96:99]
    ds_read_b128 v[188:191], v100 offset:448
    ds_read_b128 v[192:195], v101 offset:9152
    ds_read_b128 v[196:199], v101 offset:17856
    s_waitcnt lgkmcnt(6)
    v_mfma_f32_16x16x32_bf16 v[92:95], v[156:159], v[152:155], v[92:95]
    v_mfma_f32_16x16x32_bf16 v[96:99], v[160:163], v[152:155], v[96:99]
    v_mfma_f32_16x16x32_bf16 v[92:95], v[168:171], v[164:167], v[92:95]
    v_mfma_f32_16x16x32_bf16 v[96:99], v[172:175], v[164:167], v[96:99]
    s_waitcnt lgkmcnt(3)
    v_mfma_f32_16x16x32_bf16 v[92:95], v[180:183], v[176:179], v[92:95]
    v_mfma_f32_16x16x32_bf16 v[96:99], v[184:187], v[176:179], v[96:99]
    s_waitcnt lgkmcnt(0)
    v_mfma_f32_16x16x32_bf16 v[92:95], v[192:195], v[188:191], v[92:95]
    v_mfma_f32_16x16x32_bf16 v[96:99], v[196:199], v[188:191], v[96:99]
    s_nop 6
    v_cvt_pk_bf16_f32 v88, v92, v93
    v_cvt_pk_bf16_f32 v89, v94, v95
    ds_write_b64 v102, v[88:89] offset:0
    v_cvt_pk_bf16_f32 v90, v96, v97
    v_cvt_pk_bf16_f32 v91, v98, v99
    ds_write_b64 v102, v[90:91] offset:512
    s_add_u32 s92, s92, 1024
    s_add_u32 s93, s92, 1024
    s_waitcnt vmcnt(0)
    buffer_store_dwordx4 v[4:7], v248, s[8:11], s78 offen sc1
    buffer_store_dwordx4 v[4:7], v248, s[8:11], s79 offen sc1
    buffer_store_dwordx4 v[4:7], v211, s[8:11], s71 offen sc1
    v_mov_b32 v16, 0x3727c5ac
    v_mov_b32 v17, 0x3727c5ac
    s_mov_b32 s72, 147456
    s_mov_b32 s73, 155648
    s_mov_b32 s74, 151552
    s_mov_b32 s75, 159744
    s_mov_b64 exec, 0
    s_cmp_eq_u32 s33, 0
    s_cbranch_scc1 L_warm_1_0
    s_cmp_eq_u32 s33, 1
    s_cbranch_scc1 L_warm_1_1
    s_cmp_eq_u32 s33, 2
    s_cbranch_scc1 L_warm_1_2
    s_branch L_warm_1_3
L_wret_1:
    s_mov_b64 exec, -1
    s_cmp_lg_u32 s33, 0
    s_cbranch_scc1 L_skip_4
    s_mov_b32 s80, 0
    s_waitcnt vmcnt(3)
L_tp_5:
    v_xor_b32 v200, s95, v200
    v_xor_b32 v201, s95, v201
    v_xor_b32 v202, s95, v202
    v_xor_b32 v203, s95, v203
    v_or3_b32 v200, v200, v201, v202
    v_or_b32 v200, v200, v203
    v_cmp_ne_u32 vcc, 0, v200
    s_nop 0
    s_and_b64 exec, exec, vcc
    s_cbranch_scc0 L_tpx_6
    s_sleep 3
    buffer_load_dwordx4 v[200:203], v48, s[8:11], s99 offen sc1
    s_add_u32 s80, s80, 1
    s_cmp_lt_u32 s80, 400000
    s_waitcnt vmcnt(0)
    s_cbranch_scc1 L_tp_5
L_tpx_6:
    s_mov_b64 exec, -1
L_skip_4:
    s_waitcnt lgkmcnt(0)
    s_barrier
    buffer_load_dwordx4 v[24:27], v241, s[8:11], s72 offen sc1
    buffer_load_dwordx4 v[28:31], v241, s[8:11], s73 offen sc1
    buffer_load_dwordx4 v[20:23], v240, s[8:11], s4 offen sc1
    buffer_load_dwordx4 v[184:187], v241, s[8:11], s74 offen sc1
    buffer_load_dwordx4 v[188:191], v241, s[8:11], s75 offen sc1
    buffer_load_dwordx4 v[180:183], v240, s[8:11], s5 offen sc1
    s_lshl_b32 s99, s6, 11
    s_add_u32 s99, s99, 32768
    ds_read_u16 v104, v64 offset:57344
    ds_read_u16 v105, v65 offset:57344
    ds_read_u16 v106, v66 offset:57344
    ds_read_u16 v107, v67 offset:57344
    ds_read_u16 v108, v68 offset:57344
    ds_read_u16 v109, v69 offset:57344
    ds_read_u16 v110, v70 offset:57344
    ds_read_u16 v111, v71 offset:57344
    ds_read_u16 v112, v72 offset:57344
    ds_read_u16 v114, v64 offset:59392
    ds_read_u16 v115, v65 offset:59392
    ds_read_u16 v116, v66 offset:59392
    ds_read_u16 v117, v67 offset:59392
    ds_read_u16 v118, v68 offset:59392
    ds_read_u16 v119, v69 offset:59392
    ds_read_u16 v120, v70 offset:59392
    ds_read_u16 v121, v71 offset:59392
    ds_read_u16 v122, v72 offset:59392
    ds_read_b64_tr_b16 a[0:1], v217 offset:0
    ds_read_b64_tr_b16 a[2:3], v217 offset:2048
    ds_read_b64_tr_b16 a[4:5], v217 offset:4096
    ds_read_b64_tr_b16 a[6:7], v217 offset:6144
    ds_read_b64_tr_b16 a[8:9], v217 offset:8192
    ds_read_b64_tr_b16 a[10:11], v217 offset:10240
    ds_read_b64_tr_b16 a[12:13], v217 offset:12288
    ds_read_b64_tr_b16 a[14:15], v217 offset:14336
    ds_read_b64_tr_b16 a[16:17], v217 offset:16384
    ds_read_b64_tr_b16 a[18:19], v217 offset:18432
    ds_read_b64_tr_b16 a[20:21], v217 offset:20480
    ds_read_b64_tr_b16 a[22:23], v217 offset:22528
    ds_read_b64_tr_b16 a[24:25], v217 offset:24576
    ds_read_b64_tr_b16 a[26:27], v217 offset:26624
    ds_read_b64_tr_b16 a[28:29], v217 offset:28672
    ds_read_b64_tr_b16 a[30:31], v217 offset:30720
    ds_read_b64_tr_b16 a[32:33], v217 offset:32768
    ds_read_b64_tr_b16 a[34:35], v217 offset:34816
    ds_read_b64_tr_b16 a[36:37], v217 offset:36864
    ds_read_b64_tr_b16 a[38:39], v217 offset:38912
    ds_read_b64_tr_b16 a[40:41], v217 offset:40960
    ds_read_b64_tr_b16 a[42:43], v217 offset:43008
    ds_read_b64_tr_b16 a[44:45], v217 offset:45056
    ds_read_b64_tr_b16 a[46:47], v217 offset:47104
    ds_read_b64_tr_b16 a[48:49], v217 offset:49152
    ds_read_b64_tr_b16 a[50:51], v217 offset:51200
    ds_read_b64_tr_b16 a[52:53], v217 offset:53248
    ds_read_b64_tr_b16 a[54:55], v217 offset:55296
    ds_read_b64_tr_b16 a[56:57], v217 offset:57344
    ds_read_b64_tr_b16 a[58:59], v217 offset:59392
    ds_read_b64_tr_b16 a[60:61], v217 offset:61440
    ds_read_b64_tr_b16 a[62:63], v217 offset:63488
    s_mul_i32 s89, s60, 24
    s_add_u32 m0, s60, s32
    s_add_u32 s89, s89, s92
    buffer_load_dwordx4 v8, s[16:19], s89 offen offset:0 lds
    buffer_load_dwordx4 v9, s[16:19], s89 offen offset:1024 lds
    buffer_load_dwordx4 v10, s[16:19], s89 offen offset:2048 lds
    buffer_load_dwordx4 v11, s[16:19], s89 offen offset:3072 lds
    s_waitcnt lgkmcnt(8)
    v_lshl_or_b32 v160, v105, 16, v104
    v_lshl_or_b32 v161, v107, 16, v106
    v_lshl_or_b32 v162, v109, 16, v108
    v_lshl_or_b32 v163, v111, 16, v110
    ds_write_b128 v103, v[160:163] offset:0
    v_lshl_or_b32 v164, v106, 16, v105
    v_lshl_or_b32 v165, v108, 16, v107
    v_lshl_or_b32 v166, v110, 16, v109
    v_lshl_or_b32 v167, v112, 16, v111
    ds_write_b128 v103, v[164:167] offset:4160
    v_lshl_or_b32 v168, v115, 16, v114
    v_lshl_or_b32 v169, v117, 16, v116
    v_lshl_or_b32 v170, v119, 16, v118
    v_lshl_or_b32 v171, v121, 16, v120
    ds_write_b128 v103, v[168:171] offset:8320
    v_lshl_or_b32 v172, v116, 16, v115
    v_lshl_or_b32 v173, v118, 16, v117
    v_lshl_or_b32 v174, v120, 16, v119
    v_lshl_or_b32 v175, v122, 16, v121
    ds_write_b128 v103, v[172:175] offset:12480
    s_waitcnt lgkmcnt(0)
    s_barrier
    ds_write_b128 v249, v[52:55]
    ds_read2_b32 v[64:65], v244 offset0:176 offset1:177
    v_mfma_f32_16x16x32_bf16 v[4:7], a[0:3], v[236:239], 0
    ds_read2_b32 v[66:67], v244 offset0:178 offset1:179
    v_mfma_f32_16x16x32_bf16 v[4:7], a[4:7], v[236:239], v[4:7]
    ds_read2_b32 v[68:69], v244 offset0:48 offset1:49
    v_mfma_f32_16x16x32_bf16 v[4:7], a[8:11], v[236:239], v[4:7]
    ds_read2_b32 v[70:71], v244 offset0:50 offset1:51
    v_mfma_f32_16x16x32_bf16 v[4:7], a[12:15], v[236:239], v[4:7]
    ds_read2_b32 v[72:73], v245 offset0:176 offset1:177
    v_mfma_f32_16x16x32_bf16 v[4:7], a[16:19], v[236:239], v[4:7]
    ds_read2_b32 v[74:75], v245 offset0:178 offset1:179
    v_mfma_f32_16x16x32_bf16 v[4:7], a[20:23], v[236:239], v[4:7]
    ds_read2_b32 v[76:77], v245 offset0:48 offset1:49
    v_mfma_f32_16x16x32_bf16 v[4:7], a[24:27], v[236:239], v[4:7]
    ds_read2_b32 v[78:79], v245 offset0:50 offset1:51
    v_mfma_f32_16x16x32_bf16 v[4:7], a[28:31], v[236:239], v[4:7]
    ds_read2_b32 v[80:81], v244 offset0:160 offset1:161
    v_mfma_f32_16x16x32_bf16 v[4:7], a[32:35], v[236:239], v[4:7]
    ds_read2_b32 v[82:83], v244 offset0:162 offset1:163
    v_mfma_f32_16x16x32_bf16 v[4:7], a[36:39], v[236:239], v[4:7]
    ds_read2_b32 v[84:85], v244 offset0:32 offset1:33
    v_mfma_f32_16x16x32_bf16 v[4:7], a[40:43], v[236:239], v[4:7]
    ds_read2_b32 v[86:87], v244 offset0:34 offset1:35
    v_mfma_f32_16x16x32_bf16 v[4:7], a[44:47], v[236:239], v[4:7]
    ds_read2_b32 v[88:89], v245 offset0:160 offset1:161
    v_mfma_f32_16x16x32_bf16 v[4:7], a[48:51], v[236:239], v[4:7]
    ds_read2_b32 v[90:91], v245 offset0:162 offset1:163
    v_mfma_f32_16x16x32_bf16 v[4:7], a[52:55], v[236:239], v[4:7]
    ds_read2_b32 v[92:93], v245 offset0:32 offset1:33
    v_mfma_f32_16x16x32_bf16 v[4:7], a[56:59], v[236:239], v[4:7]
    ds_read2_b32 v[94:95], v245 offset0:34 offset1:35
    v_mfma_f32_16x16x32_bf16 v[4:7], a[60:63], v[236:239], v[4:7]
    s_mul_i32 s89, s61, 24
    s_add_u32 m0, s61, s32
    s_add_u32 s89, s89, s92
    buffer_load_dwordx4 v8, s[16:19], s89 offen offset:0 lds
    buffer_load_dwordx4 v9, s[16:19], s89 offen offset:1024 lds
    buffer_load_dwordx4 v10, s[16:19], s89 offen offset:2048 lds
    buffer_load_dwordx4 v11, s[16:19], s89 offen offset:3072 lds
    s_waitcnt vmcnt(13)
    v_pk_mul_f32 v[24:25], v[24:25], s[82:83]
    v_pk_mul_f32 v[26:27], v[26:27], s[82:83]
    s_waitcnt vmcnt(12)
    v_pk_fma_f32 v[28:29], v[28:29], s[82:83], v[16:17]
    v_pk_fma_f32 v[30:31], v[30:31], s[82:83], v[16:17]
    v_pk_fma_f32 v[28:29], v[24:25], v[24:25], v[28:29] neg_lo:[1,0,0] neg_hi:[1,0,0]
    v_pk_fma_f32 v[30:31], v[26:27], v[26:27], v[30:31] neg_lo:[1,0,0] neg_hi:[1,0,0]
    v_max_f32 v28, v16, v28
    v_max_f32 v29, v16, v29
    v_max_f32 v30, v16, v30
    v_max_f32 v31, v16, v31
    v_rsq_f32 v28, v28
    v_rsq_f32 v29, v29
    v_rsq_f32 v30, v30
    v_rsq_f32 v31, v31
    s_waitcnt vmcnt(11)
    v_lshlrev_b32 v48, 16, v20
    v_and_b32 v49, 0xffff0000, v20
    v_lshlrev_b32 v50, 16, v21
    v_and_b32 v51, 0xffff0000, v21
    v_lshlrev_b32 v52, 16, v22
    v_and_b32 v53, 0xffff0000, v22
L_warm_0_0:
    s_cbranch_execz L_wret_0
    v_lshlrev_b32 v54, 16, v23
    v_and_b32 v55, 0xffff0000, v23
    v_pk_mul_f32 v[24:25], v[24:25], v[28:29]
    v_pk_mul_f32 v[26:27], v[26:27], v[30:31]
    v_pk_fma_f32 v[32:33], v[48:49], v[28:29], v[24:25] neg_lo:[0,0,1] neg_hi:[0,0,1]
    v_pk_fma_f32 v[34:35], v[50:51], v[30:31], v[26:27] neg_lo:[0,0,1] neg_hi:[0,0,1]
    v_pk_fma_f32 v[36:37], v[52:53], v[28:29], v[24:25] neg_lo:[0,0,1] neg_hi:[0,0,1]
    v_pk_fma_f32 v[38:39], v[54:55], v[30:31], v[26:27] neg_lo:[0,0,1] neg_hi:[0,0,1]
    v_cvt_pk_bf16_f32 v20, v32, v33
    v_cvt_pk_bf16_f32 v22, v36, v37
    v_cvt_pk_bf16_f32 v21, v34, v35
    v_cvt_pk_bf16_f32 v23, v38, v39
    v_permlane16_swap_b32 v20, v22
    s_nop 0
    v_permlane16_swap_b32 v21, v23
    ds_write_b128 v242, v[20:23] offset:0
    v_pk_fma_f32 v[48:49], v[32:33], s[30:31], v[48:49] op_sel:[0,0,0] op_sel_hi:[1,0,1]
    v_pk_fma_f32 v[50:51], v[34:35], s[30:31], v[50:51] op_sel:[0,0,0] op_sel_hi:[1,0,1]
    v_pk_fma_f32 v[52:53], v[36:37], s[30:31], v[52:53] op_sel:[0,1,0] op_sel_hi:[1,1,1]
    v_pk_fma_f32 v[54:55], v[38:39], s[30:31], v[54:55] op_sel:[0,1,0] op_sel_hi:[1,1,1]
    s_waitcnt vmcnt(10)
    v_pk_mul_f32 v[184:185], v[184:185], s[82:83]
    v_pk_mul_f32 v[186:187], v[186:187], s[82:83]
    s_waitcnt vmcnt(9)
    v_pk_fma_f32 v[188:189], v[188:189], s[82:83], v[16:17]
    v_pk_fma_f32 v[190:191], v[190:191], s[82:83], v[16:17]
    v_pk_fma_f32 v[188:189], v[184:185], v[184:185], v[188:189] neg_lo:[1,0,0] neg_hi:[1,0,0]
    v_pk_fma_f32 v[190:191], v[186:187], v[186:187], v[190:191] neg_lo:[1,0,0] neg_hi:[1,0,0]
    v_max_f32 v188, v16, v188
    v_max_f32 v189, v16, v189
    v_max_f32 v190, v16, v190
    v_max_f32 v191, v16, v191
    v_rsq_f32 v188, v188
    v_rsq_f32 v189, v189
    v_rsq_f32 v190, v190
    v_rsq_f32 v191, v191
    s_waitcnt vmcnt(8)
    v_lshlrev_b32 v56, 16, v180
    v_and_b32 v57, 0xffff0000, v180
    v_lshlrev_b32 v58, 16, v181
    v_and_b32 v59, 0xffff0000, v181
    v_lshlrev_b32 v60, 16, v182
    v_and_b32 v61, 0xffff0000, v182
    v_lshlrev_b32 v62, 16, v183
    v_and_b32 v63, 0xffff0000, v183
    v_pk_mul_f32 v[184:185], v[184:185], v[188:189]
    v_pk_mul_f32 v[186:187], v[186:187], v[190:191]
    v_pk_fma_f32 v[192:193], v[56:57], v[188:189], v[184:185] neg_lo:[0,0,1] neg_hi:[0,0,1]
    v_pk_fma_f32 v[194:195], v[58:59], v[190:191], v[186:187] neg_lo:[0,0,1] neg_hi:[0,0,1]
    v_pk_fma_f32 v[196:197], v[60:61], v[188:189], v[184:185] neg_lo:[0,0,1] neg_hi:[0,0,1]
    v_pk_fma_f32 v[198:199], v[62:63], v[190:191], v[186:187] neg_lo:[0,0,1] neg_hi:[0,0,1]
    v_cvt_pk_bf16_f32 v180, v192, v193
    v_cvt_pk_bf16_f32 v182, v196, v197
    v_cvt_pk_bf16_f32 v181, v194, v195
    v_cvt_pk_bf16_f32 v183, v198, v199
    v_permlane16_swap_b32 v180, v182
    s_nop 0
    v_permlane16_swap_b32 v181, v183
    ds_write_b128 v242, v[180:183] offset:2048
    v_pk_fma_f32 v[56:57], v[192:193], s[30:31], v[56:57] op_sel:[0,0,0] op_sel_hi:[1,0,1]
    v_pk_fma_f32 v[58:59], v[194:195], s[30:31], v[58:59] op_sel:[0,0,0] op_sel_hi:[1,0,1]
    v_pk_fma_f32 v[60:61], v[196:197], s[30:31], v[60:61] op_sel:[0,1,0] op_sel_hi:[1,1,1]
    v_pk_fma_f32 v[62:63], v[198:199], s[30:31], v[62:63] op_sel:[0,1,0] op_sel_hi:[1,1,1]
    s_waitcnt lgkmcnt(0)
    s_barrier
    ds_read_b128 v[128:131], v243 offset:192
    ds_read_b128 v[132:135], v243 offset:704
    ds_read_b128 v[136:139], v243 offset:1216
    s_mul_i32 s76, s69, 240
    v_add_u32 v200, s76, v243
    v_and_b32 v12, 7, v1
    v_lshlrev_b32 v12, 2, v12
    s_waitcnt lgkmcnt(2)
    v_mfma_f32_16x16x32_bf16 v[16:19], v[64:67], v[128:131], 0
    ds_read_b128 a[208:211], v249
    s_mul_i32 s89, s62, 24
    v_mfma_f32_16x16x32_bf16 v[20:23], v[68:71], v[128:131], 0
    s_add_u32 m0, s62, s32
    s_add_u32 s89, s89, s92
    buffer_load_dwordx4 v8, s[16:19], s89 offen offset:0 lds
    v_mfma_f32_16x16x32_bf16 v[24:27], v[72:75], v[128:131], 0
    ds_read_b128 v[140:143], v243 offset:1728
    v_mfma_f32_16x16x32_bf16 v[28:31], v[76:79], v[128:131], 0
    ds_read2_b32 v[96:97], v244 offset0:144 offset1:145
    s_waitcnt lgkmcnt(3)
    v_mfma_f32_16x16x32_bf16 v[20:23], v[64:67], v[132:135], v[20:23]
    ds_read_b128 v[144:147], v200 offset:192
    v_mfma_f32_16x16x32_bf16 v[24:27], v[68:71], v[132:135], v[24:27]
    buffer_load_dwordx4 v9, s[16:19], s89 offen offset:1024 lds
    v_mfma_f32_16x16x32_bf16 v[28:31], v[72:75], v[132:135], v[28:31]
    ds_read2_b32 v[98:99], v244 offset0:146 offset1:147
    ds_read_b128 v[148:151], v200 offset:704
    ds_read_b128 v[152:155], v200 offset:1216
    v_mfma_f32_16x16x32_bf16 v[24:27], v[64:67], v[136:139], v[24:27]
    ds_read2_b32 v[100:101], v244 offset0:16 offset1:17
    ds_read_b128 v[156:159], v200 offset:1728
    v_mfma_f32_16x16x32_bf16 v[28:31], v[68:71], v[136:139], v[28:31]
    ds_read2_b32 v[102:103], v244 offset0:18 offset1:19
    ds_read_b128 v[160:163], v243 offset:128
    s_waitcnt lgkmcnt(8)
    v_mfma_f32_16x16x32_bf16 v[28:31], v[64:67], v[140:143], v[28:31]
    buffer_load_dwordx4 v10, s[16:19], s89 offen offset:2048 lds
    s_waitcnt lgkmcnt(7)
    v_mfma_f32_16x16x32_bf16 v[32:35], v[144:147], a[208:211], 0
    ds_read2_b32 v[104:105], v245 offset0:144 offset1:145
    s_waitcnt lgkmcnt(6)
    v_mfma_f32_16x16x32_bf16 v[36:39], v[148:151], a[208:211], 0
    ds_read2_b32 v[106:107], v245 offset0:146 offset1:147
    s_waitcnt lgkmcnt(6)
    v_mfma_f32_16x16x32_bf16 v[40:43], v[152:155], a[208:211], 0
    ds_read_b128 v[164:167], v243 offset:640
    s_waitcnt lgkmcnt(5)
    v_mfma_f32_16x16x32_bf16 v[44:47], v[156:159], a[208:211], 0
    buffer_load_dwordx4 v11, s[16:19], s89 offen offset:3072 lds
    s_waitcnt lgkmcnt(3)
    v_mfma_f32_16x16x32_bf16 v[16:19], v[80:83], v[160:163], v[16:19]
    ds_read2_b32 v[108:109], v245 offset0:16 offset1:17
    v_cvt_pk_bf16_f32 v172, v32, v33
    v_mfma_f32_16x16x32_bf16 v[20:23], v[84:87], v[160:163], v[20:23]
    ds_read2_b32 v[110:111], v245 offset0:18 offset1:19
    ds_read_b128 v[168:171], v243 offset:1152
    v_mfma_f32_16x16x32_bf16 v[24:27], v[88:91], v[160:163], v[24:27]
    ds_read2_b32 v[112:113], v244 offset0:128 offset1:129
    v_cvt_pk_bf16_f32 v173, v34, v35
    v_mfma_f32_16x16x32_bf16 v[28:31], v[92:95], v[160:163], v[28:31]
    buffer_load_dword v13, v12, s[8:11], s100 offen sc1
    s_waitcnt lgkmcnt(4)
    v_mfma_f32_16x16x32_bf16 v[20:23], v[80:83], v[164:167], v[20:23]
    ds_read2_b32 v[114:115], v244 offset0:130 offset1:131
    ds_read_b128 v[128:131], v243 offset:1664
    ds_read_b128 v[132:135], v243 offset:64
    v_mfma_f32_16x16x32_bf16 v[24:27], v[84:87], v[164:167], v[24:27]
    ds_read2_b32 v[116:117], v244 offset0:0 offset1:1
    v_cvt_pk_bf16_f32 v174, v36, v37
    v_mfma_f32_16x16x32_bf16 v[28:31], v[88:91], v[164:167], v[28:31]
    ds_read2_b32 v[118:119], v244 offset0:2 offset1:3
    s_waitcnt lgkmcnt(6)
    v_mfma_f32_16x16x32_bf16 v[24:27], v[80:83], v[168:171], v[24:27]
    s_add_u32 m0, s63, s32
    s_mul_i32 s89, s63, 24
    s_add_u32 s89, s89, s92
    buffer_load_dwordx4 v8, s[16:19], s89 offen offset:0 lds
    v_mfma_f32_16x16x32_bf16 v[28:31], v[84:87], v[168:171], v[28:31]
    ds_read2_b32 v[120:121], v245 offset0:128 offset1:129
    ds_read_b128 v[136:139], v243 offset:576
    s_waitcnt lgkmcnt(4)
    v_mfma_f32_16x16x32_bf16 v[28:31], v[80:83], v[128:131], v[28:31]
    ds_read2_b32 v[122:123], v245 offset0:130 offset1:131
    v_cvt_pk_bf16_f32 v175, v38, v39
    v_mfma_f32_16x16x32_bf16 v[16:19], v[96:99], v[132:135], v[16:19]
    ds_read2_b32 v[124:125], v245 offset0:0 offset1:1
    v_cvt_pk_bf16_f32 v176, v40, v41
    v_mfma_f32_16x16x32_bf16 v[20:23], v[100:103], v[132:135], v[20:23]
    ds_read_b128 v[140:143], v243 offset:1088
    v_cvt_pk_bf16_f32 v177, v42, v43
    v_mfma_f32_16x16x32_bf16 v[24:27], v[104:107], v[132:135], v[24:27]
    buffer_load_dwordx4 v9, s[16:19], s89 offen offset:1024 lds
    v_mfma_f32_16x16x32_bf16 v[28:31], v[108:111], v[132:135], v[28:31]
    ds_read2_b32 v[126:127], v245 offset0:2 offset1:3
    ds_read_b128 v[144:147], v243 offset:1600
    s_waitcnt lgkmcnt(5)
    v_mfma_f32_16x16x32_bf16 v[20:23], v[96:99], v[136:139], v[20:23]
    ds_read2_b32 a[192:193], v246 offset0:176 offset1:177
    ds_read_b128 v[148:151], v243 offset:0
    v_mfma_f32_16x16x32_bf16 v[24:27], v[100:103], v[136:139], v[24:27]
    ds_read2_b32 a[194:195], v246 offset0:178 offset1:179
    ds_read_b128 v[152:155], v243 offset:512
    v_mfma_f32_16x16x32_bf16 v[28:31], v[104:107], v[136:139], v[28:31]
    buffer_load_dwordx4 v10, s[16:19], s89 offen offset:2048 lds
    s_waitcnt lgkmcnt(6)
    v_mfma_f32_16x16x32_bf16 v[24:27], v[96:99], v[140:143], v[24:27]
    ds_read2_b32 a[196:197], v247 offset0:0 offset1:1
    ds_read_b128 v[156:159], v243 offset:1024
    v_mfma_f32_16x16x32_bf16 v[28:31], v[100:103], v[140:143], v[28:31]
    ds_read2_b32 a[198:199], v247 offset0:8 offset1:9
    s_waitcnt lgkmcnt(7)
    v_mfma_f32_16x16x32_bf16 v[28:31], v[96:99], v[144:147], v[28:31]
    ds_read2_b32 a[200:201], v247 offset0:16 offset1:17
    s_waitcnt lgkmcnt(6)
    v_mfma_f32_16x16x32_bf16 v[16:19], v[112:115], v[148:151], v[16:19]
    ds_read_b128 v[160:163], v243 offset:1536
    s_waitcnt lgkmcnt(5)
    v_mfma_f32_16x16x32_bf16 v[20:23], v[112:115], v[152:155], v[20:23]
    buffer_load_dwordx4 v11, s[16:19], s89 offen offset:3072 lds
    v_mfma_f32_16x16x32_bf16 v[20:23], v[116:119], v[148:151], v[20:23]
    ds_read2_b32 a[202:203], v247 offset0:24 offset1:25
    s_waitcnt lgkmcnt(4)
    v_mfma_f32_16x16x32_bf16 v[24:27], v[112:115], v[156:159], v[24:27]
    ds_read2_b32 a[204:205], v247 offset0:32 offset1:33
    v_cvt_pk_bf16_f32 v178, v44, v45
    v_mfma_f32_16x16x32_bf16 v[24:27], v[116:119], v[152:155], v[24:27]
    v_cvt_pk_bf16_f32 v179, v46, v47
    s_mul_i32 s89, s45, 24
    v_mfma_f32_16x16x32_bf16 v[24:27], v[120:123], v[148:151], v[24:27]
    s_add_u32 m0, s45, s88
    s_add_u32 s89, s89, s93
    buffer_load_dwordx4 v8, s[16:19], s89 offen offset:0 lds
    s_waitcnt lgkmcnt(2)
    v_mfma_f32_16x16x32_bf16 v[28:31], v[112:115], v[160:163], v[28:31]
    v_mfma_f32_16x16x32_bf16 v[28:31], v[116:119], v[156:159], v[28:31]
    ds_write_b128 v250, v[16:19] offset:0
    v_mfma_f32_16x16x32_bf16 v[28:31], v[120:123], v[152:155], v[28:31]
    v_mfma_f32_16x16x32_bf16 v[28:31], v[124:127], v[148:151], v[28:31]
    buffer_load_dwordx4 v9, s[16:19], s89 offen offset:1024 lds
    v_mfma_f32_16x16x32_bf16 v[32:35], v[124:127], v[152:155], 0
    ds_write_b128 v250, v[20:23] offset:1024
    v_mfma_f32_16x16x32_bf16 v[32:35], v[120:123], v[156:159], v[32:35]
    v_mfma_f32_16x16x32_bf16 v[36:39], v[124:127], v[156:159], 0
    v_mfma_f32_16x16x32_bf16 v[32:35], v[116:119], v[160:163], v[32:35]
    ds_write_b128 v250, v[24:27] offset:2048
    v_mfma_f32_16x16x32_bf16 v[36:39], v[120:123], v[160:163], v[36:39]
    buffer_load_dwordx4 v10, s[16:19], s89 offen offset:2048 lds
    v_mfma_f32_16x16x32_bf16 v[40:43], v[124:127], v[160:163], 0
    ds_read_b128 v[164:167], v243 offset:640
    v_mfma_f32_16x16x32_bf16 v[32:35], v[108:111], v[136:139], v[32:35]
    ds_write_b128 v250, v[28:31] offset:3072
    v_mfma_f32_16x16x32_bf16 v[32:35], v[104:107], v[140:143], v[32:35]
    ds_read_b128 v[168:171], v243 offset:1152
    v_mfma_f32_16x16x32_bf16 v[36:39], v[108:111], v[140:143], v[36:39]
    buffer_load_dwordx4 v11, s[16:19], s89 offen offset:3072 lds
    v_mfma_f32_16x16x32_bf16 v[32:35], v[100:103], v[144:147], v[32:35]
    ds_read_b128 v[128:131], v243 offset:1664
    s_mul_i32 s89, s46, 24
    v_mfma_f32_16x16x32_bf16 v[36:39], v[104:107], v[144:147], v[36:39]
    s_waitcnt lgkmcnt(2)
    s_barrier
    ds_read_b128 v[132:135], v243 offset:192
    v_mfma_f32_16x16x32_bf16 v[40:43], v[108:111], v[144:147], v[40:43]
    ds_read_b128 v[136:139], v243 offset:704
    ds_read_b128 v[16:19], v251 offset:0
    v_mfma_f32_16x16x32_bf16 v[32:35], v[92:95], v[164:167], v[32:35]
    s_add_u32 m0, s46, s88
    s_add_u32 s89, s89, s93
    buffer_load_dwordx4 v8, s[16:19], s89 offen offset:0 lds
    s_waitcnt lgkmcnt(4)
    v_mfma_f32_16x16x32_bf16 v[32:35], v[88:91], v[168:171], v[32:35]
    ds_read_b128 v[140:143], v243 offset:1216
    ds_read_b128 v[20:23], v251 offset:4096
    v_mfma_f32_16x16x32_bf16 v[36:39], v[92:95], v[168:171], v[36:39]
    ds_read_b128 v[24:27], v251 offset:8192
    s_waitcnt lgkmcnt(6)
    v_mfma_f32_16x16x32_bf16 v[32:35], v[84:87], v[128:131], v[32:35]
    ds_read_b128 v[144:147], v243 offset:1728
    ds_read_b128 v[28:31], v251 offset:12288
    v_mfma_f32_16x16x32_bf16 v[36:39], v[88:91], v[128:131], v[36:39]
    buffer_load_dwordx4 v9, s[16:19], s89 offen offset:1024 lds
    v_mfma_f32_16x16x32_bf16 v[40:43], v[92:95], v[128:131], v[40:43]
    s_waitcnt lgkmcnt(5)
    v_add_f32 v48, v48, v16
    v_mfma_f32_16x16x32_bf16 v[32:35], a[192:195], v[132:135], v[32:35]
    v_add_f32 v49, v49, v17
    v_add_f32 v50, v50, v18
    v_mfma_f32_16x16x32_bf16 v[32:35], v[76:79], v[136:139], v[32:35]
    v_add_f32 v51, v51, v19
    s_waitcnt lgkmcnt(2)
    v_add_f32 v48, v48, v20
    v_mfma_f32_16x16x32_bf16 v[36:39], a[192:195], v[136:139], v[36:39]
    buffer_load_dwordx4 v10, s[16:19], s89 offen offset:2048 lds
    v_mfma_f32_16x16x32_bf16 v[32:35], v[72:75], v[140:143], v[32:35]
    v_add_f32 v49, v49, v21
    v_add_f32 v50, v50, v22
    v_mfma_f32_16x16x32_bf16 v[36:39], v[76:79], v[140:143], v[36:39]
    v_add_f32 v51, v51, v23
    v_add_f32 v52, v52, v24
    v_mfma_f32_16x16x32_bf16 v[40:43], a[192:195], v[140:143], v[40:43]
    v_add_f32 v53, v53, v25
    s_waitcnt lgkmcnt(0)
    v_mfma_f32_16x16x32_bf16 v[32:35], v[68:71], v[144:147], v[32:35]
    buffer_load_dwordx4 v11, s[16:19], s89 offen offset:3072 lds
    v_mfma_f32_16x16x32_bf16 v[36:39], v[72:75], v[144:147], v[36:39]
    ds_read_b128 v[148:151], v243 offset:2240
    v_add_f32 v54, v54, v26
    v_mfma_f32_16x16x32_bf16 v[40:43], v[76:79], v[144:147], v[40:43]
    v_add_f32 v55, v55, v27
    v_add_f32 v52, v52, v28
    v_mfma_f32_16x16x32_bf16 v[44:47], a[192:195], v[144:147], 0
    v_add_f32 v53, v53, v29
    v_add_f32 v54, v54, v30
    v_mfma_f32_16x16x32_bf16 v[32:35], v[172:175], a[202:205], v[32:35]
    s_add_u32 m0, s47, s88
    s_mul_i32 s89, s47, 24
    s_add_u32 s89, s89, s93
    buffer_load_dwordx4 v8, s[16:19], s89 offen offset:0 lds
    v_mfma_f32_16x16x32_bf16 v[36:39], v[172:175], a[200:203], v[36:39]
    ds_read_b128 v[152:155], v243 offset:2752
    v_add_f32 v55, v55, v31
    v_mfma_f32_16x16x32_bf16 v[40:43], v[172:175], a[198:201], v[40:43]
    v_cvt_pk_bf16_f32 v200, v48, v49
    v_cvt_pk_bf16_f32 v202, v52, v53
    v_mfma_f32_16x16x32_bf16 v[44:47], v[172:175], a[196:199], v[44:47]
    v_cvt_pk_bf16_f32 v201, v50, v51
    v_cvt_pk_bf16_f32 v203, v54, v55
    v_mfma_f32_16x16x32_bf16 v[40:43], v[176:179], a[202:205], v[40:43]
    v_permlane16_swap_b32 v200, v202
    v_permlane16_swap_b32 v201, v203
    buffer_store_dwordx4 v[200:203], v248, s[8:11], s78 offen sc1
    s_waitcnt vmcnt(10)
    s_barrier
    ds_read_b128 v[156:159], v243 offset:3264
    v_mfma_f32_16x16x32_bf16 v[44:47], v[176:179], a[200:203], v[44:47]
    v_mov_b32 v16, 1
    s_mov_b64 exec, s[0:1]
    buffer_atomic_add v16, v252, s[8:11], s98 offen sc1
    s_mov_b64 exec, -1
    s_waitcnt lgkmcnt(1)
    v_mfma_f32_16x16x32_bf16 v[32:35], v[64:67], v[148:151], v[32:35]
    buffer_load_dwordx4 v9, s[16:19], s89 offen offset:1024 lds
    v_mfma_f32_16x16x32_bf16 v[36:39], v[68:71], v[148:151], v[36:39]
    ds_read_b128 v[160:163], v243 offset:3776
    ds_read_b64_tr_b16 a[64:65], v208 offset:0
    v_mfma_f32_16x16x32_bf16 v[40:43], v[72:75], v[148:151], v[40:43]
    ds_read_b128 v[164:167], v243 offset:2176
    ds_read_b64_tr_b16 a[66:67], v208 offset:2048
    v_mfma_f32_16x16x32_bf16 v[44:47], v[76:79], v[148:151], v[44:47]
    ds_read_b64_tr_b16 a[68:69], v208 offset:4096
    ds_read_b64_tr_b16 a[70:71], v208 offset:6144
    v_mfma_f32_16x16x32_bf16 v[36:39], v[64:67], v[152:155], v[36:39]
    buffer_load_dwordx4 v10, s[16:19], s89 offen offset:2048 lds
    v_mfma_f32_16x16x32_bf16 v[40:43], v[68:71], v[152:155], v[40:43]
    ds_read_b128 v[168:171], v243 offset:2688
    ds_read_b64_tr_b16 a[72:73], v208 offset:8192
    v_mfma_f32_16x16x32_bf16 v[44:47], v[72:75], v[152:155], v[44:47]
    ds_read_b64_tr_b16 a[74:75], v208 offset:10240
    s_waitcnt lgkmcnt(7)
    v_mfma_f32_16x16x32_bf16 v[40:43], v[64:67], v[156:159], v[40:43]
    ds_read_b64_tr_b16 a[76:77], v208 offset:12288
    ds_read_b64_tr_b16 a[78:79], v208 offset:14336
    v_mfma_f32_16x16x32_bf16 v[44:47], v[68:71], v[156:159], v[44:47]
    buffer_load_dwordx4 v11, s[16:19], s89 offen offset:3072 lds
    v_mfma_f32_16x16x32_bf16 v[44:47], v[64:67], v[160:163], v[44:47]
    ds_read_b128 v[128:131], v243 offset:3200
    s_waitcnt lgkmcnt(6)
    v_mfma_f32_16x16x32_bf16 v[32:35], v[80:83], v[164:167], v[32:35]
    ds_read_b128 v[132:135], v243 offset:3712
    ds_read_b64_tr_b16 a[80:81], v208 offset:16384
    v_mfma_f32_16x16x32_bf16 v[36:39], v[84:87], v[164:167], v[36:39]
    ds_read_b128 v[136:139], v243 offset:2112
    ds_read_b64_tr_b16 a[82:83], v208 offset:18432
    v_mfma_f32_16x16x32_bf16 v[40:43], v[88:91], v[164:167], v[40:43]
    ds_read_b128 v[140:143], v243 offset:2048
    ds_read_b64_tr_b16 a[84:85], v208 offset:20480
    v_mfma_f32_16x16x32_bf16 v[44:47], v[92:95], v[164:167], v[44:47]
    ds_read_b64_tr_b16 a[86:87], v208 offset:22528
    s_waitcnt lgkmcnt(8)
    v_mfma_f32_16x16x32_bf16 v[36:39], v[80:83], v[168:171], v[36:39]
    ds_read_b64_tr_b16 a[88:89], v208 offset:24576
    ds_read_b64_tr_b16 a[90:91], v208 offset:26624
    v_mfma_f32_16x16x32_bf16 v[40:43], v[84:87], v[168:171], v[40:43]
    ds_read_b128 v[144:147], v243 offset:2624
    ds_read_b64_tr_b16 a[92:93], v208 offset:28672
    v_mfma_f32_16x16x32_bf16 v[44:47], v[88:91], v[168:171], v[44:47]
    ds_read_b128 v[148:151], v243 offset:2560
    s_waitcnt lgkmcnt(8)
    v_mfma_f32_16x16x32_bf16 v[40:43], v[80:83], v[128:131], v[40:43]
    ds_read_b64_tr_b16 a[94:95], v208 offset:30720
    ds_read_b64_tr_b16 a[96:97], v208 offset:32768
    v_mfma_f32_16x16x32_bf16 v[44:47], v[84:87], v[128:131], v[44:47]
    ds_read_b64_tr_b16 a[98:99], v208 offset:34816
    ds_read_b64_tr_b16 a[100:101], v208 offset:36864
    v_mfma_f32_16x16x32_bf16 v[44:47], v[80:83], v[132:135], v[44:47]
    ds_read_b64_tr_b16 a[102:103], v208 offset:38912
    ds_read_b64_tr_b16 a[104:105], v208 offset:40960
    v_mfma_f32_16x16x32_bf16 v[32:35], v[96:99], v[136:139], v[32:35]
    ds_read_b64_tr_b16 a[106:107], v208 offset:43008
    s_waitcnt lgkmcnt(8)
    v_mfma_f32_16x16x32_bf16 v[32:35], v[112:115], v[140:143], v[32:35]
    ds_read_b128 v[152:155], v243 offset:3136
    ds_read_b64_tr_b16 a[108:109], v208 offset:45056
    v_mfma_f32_16x16x32_bf16 v[36:39], v[100:103], v[136:139], v[36:39]
    ds_read_b128 v[156:159], v243 offset:3072
    ds_read_b64_tr_b16 a[110:111], v208 offset:47104
    v_mfma_f32_16x16x32_bf16 v[36:39], v[116:119], v[140:143], v[36:39]
    ds_read_b64_tr_b16 a[112:113], v208 offset:49152
    ds_read_b64_tr_b16 a[114:115], v208 offset:51200
    ds_write_b128 v250, v[32:35] offset:0
    v_mfma_f32_16x16x32_bf16 v[36:39], v[96:99], v[144:147], v[36:39]
    ds_read_b64_tr_b16 a[116:117], v208 offset:53248
    s_waitcnt lgkmcnt(7)
    v_mfma_f32_16x16x32_bf16 v[36:39], v[112:115], v[148:151], v[36:39]
    ds_read_b64_tr_b16 a[118:119], v208 offset:55296
    ds_read_b64_tr_b16 a[120:121], v208 offset:57344
    v_mfma_f32_16x16x32_bf16 v[40:43], v[104:107], v[136:139], v[40:43]
    ds_read_b64_tr_b16 a[122:123], v208 offset:59392
    ds_read_b64_tr_b16 a[124:125], v208 offset:61440
    v_mfma_f32_16x16x32_bf16 v[40:43], v[120:123], v[140:143], v[40:43]
    ds_read_b64_tr_b16 a[126:127], v208 offset:63488
    s_add_u32 s4, s4, 7602176
    ds_write_b128 v250, v[36:39] offset:1024
    v_mfma_f32_16x16x32_bf16 v[40:43], v[100:103], v[144:147], v[40:43]
    s_add_u32 s5, s5, 7602176
    s_add_u32 s78, s78, 7602176
    v_mfma_f32_16x16x32_bf16 v[40:43], v[116:119], v[148:151], v[40:43]
    ds_read_b128 v[160:163], v243 offset:3648
    v_cmp_ne_u32 s[100:101], s101, v13
    v_mfma_f32_16x16x32_bf16 v[40:43], v[96:99], v[152:155], v[40:43]
    s_bitcmp1_b32 s2, 2
    s_cbranch_scc1 L_ne_7
    v_mov_b32 v219, 0
    s_mov_b64 exec, s[58:59]
    buffer_atomic_add v219, v253, s[8:11], s99 offen sc0 sc1
    s_mov_b64 exec, -1
L_ne_7:
    ds_read_b128 v[164:167], v243 offset:3584
    s_waitcnt lgkmcnt(2)
    v_mfma_f32_16x16x32_bf16 v[40:43], v[112:115], v[156:159], v[40:43]
    s_or_b32 s101, s100, s101
    v_mfma_f32_16x16x32_bf16 v[44:47], v[108:111], v[136:139], v[44:47]
    s_cmp_eq_u32 s101, 0
    s_cselect_b32 s72, 0, 5373952
    s_cselect_b32 s100, 0, 7602176
    v_mfma_f32_16x16x32_bf16 v[44:47], v[124:127], v[140:143], v[44:47]
    s_add_u32 s41, s41, s72
    s_add_u32 s44, s44, s72
    ds_write_b128 v250, v[40:43] offset:2048
    v_mfma_f32_16x16x32_bf16 v[44:47], v[104:107], v[144:147], v[44:47]
    s_add_u32 s42, s41, 131584
    v_mfma_f32_16x16x32_bf16 v[44:47], v[120:123], v[148:151], v[44:47]
    v_mfma_f32_16x16x32_bf16 v[44:47], v[100:103], v[152:155], v[44:47]
    v_mfma_f32_16x16x32_bf16 v[44:47], v[116:119], v[156:159], v[44:47]
    s_waitcnt lgkmcnt(1)
    v_mfma_f32_16x16x32_bf16 v[44:47], v[96:99], v[160:163], v[44:47]
    v_mfma_f32_16x16x32_bf16 v[44:47], v[112:115], v[164:167], v[44:47]
    s_nop 7
    ds_write_b128 v250, v[44:47] offset:3072
    s_waitcnt lgkmcnt(0)
    s_barrier
    ds_read_b128 v[64:67], v251 offset:0
    ds_read_b128 v[68:71], v251 offset:4096
    ds_read_b128 v[72:75], v251 offset:8192
    ds_read_b128 v[76:79], v251 offset:12288
    s_waitcnt lgkmcnt(3)
    v_pk_add_f32 v[56:57], v[56:57], v[64:65]
    v_pk_add_f32 v[58:59], v[58:59], v[66:67]
    s_waitcnt lgkmcnt(2)
    v_pk_add_f32 v[56:57], v[56:57], v[68:69]
    v_pk_add_f32 v[58:59], v[58:59], v[70:71]
    s_waitcnt lgkmcnt(1)
    v_pk_add_f32 v[60:61], v[60:61], v[72:73]
    v_pk_add_f32 v[62:63], v[62:63], v[74:75]
    s_waitcnt lgkmcnt(0)
    v_pk_add_f32 v[60:61], v[60:61], v[76:77]
    v_pk_add_f32 v[62:63], v[62:63], v[78:79]
    v_cvt_pk_bf16_f32 v200, v56, v57
    v_cvt_pk_bf16_f32 v202, v60, v61
    v_cvt_pk_bf16_f32 v201, v58, v59
    v_cvt_pk_bf16_f32 v203, v62, v63
    v_permlane16_swap_b32 v200, v202
    s_nop 0
    v_permlane16_swap_b32 v201, v203
    buffer_store_dwordx4 v[200:203], v248, s[8:11], s79 offen sc1
    s_waitcnt vmcnt(1)
    s_barrier
    v_mov_b32 v16, 1
    s_mov_b64 exec, s[56:57]
    buffer_atomic_add v16, v252, s[8:11], s98 offen sc1
    s_mov_b64 exec, -1
    s_add_u32 s98, s98, 32768
    s_add_u32 m0, s88, 49152
    s_add_u32 s89, s93, 1179648
    buffer_load_dwordx4 v8, s[16:19], s89 offen offset:0 lds
    buffer_load_dwordx4 v9, s[16:19], s89 offen offset:1024 lds
    buffer_load_dwordx4 v10, s[16:19], s89 offen offset:2048 lds
    buffer_load_dwordx4 v11, s[16:19], s89 offen offset:3072 lds
    v_mfma_f32_16x16x32_bf16 v[8:11], a[64:67], v[236:239], 0
    ds_read_b64_tr_b16 a[128:129], v217 offset:0
    s_add_u32 s79, s79, 7602176
    v_mfma_f32_16x16x32_bf16 v[8:11], a[68:71], v[236:239], v[8:11]
    ds_read_b64_tr_b16 a[130:131], v217 offset:2048
    v_subrev_u32 v250, s7, v250
    v_mfma_f32_16x16x32_bf16 v[8:11], a[72:75], v[236:239], v[8:11]
    ds_read_b64_tr_b16 a[132:133], v217 offset:4096
    v_subrev_u32 v251, s7, v251
    v_mfma_f32_16x16x32_bf16 v[8:11], a[76:79], v[236:239], v[8:11]
    ds_read_b64_tr_b16 a[134:135], v217 offset:6144
    v_lshrrev_b32 v16, 3, v1
    v_mfma_f32_16x16x32_bf16 v[8:11], a[80:83], v[236:239], v[8:11]
    ds_read_b64_tr_b16 a[136:137], v217 offset:8192
    v_and_b32 v17, 6, v16
    v_mfma_f32_16x16x32_bf16 v[8:11], a[84:87], v[236:239], v[8:11]
    ds_read_b64_tr_b16 a[138:139], v217 offset:10240
    v_and_b32 v18, 7, v1
    v_mfma_f32_16x16x32_bf16 v[8:11], a[88:91], v[236:239], v[8:11]
    ds_read_b64_tr_b16 a[140:141], v217 offset:12288
    v_xor_b32 v17, v17, v18
    v_mfma_f32_16x16x32_bf16 v[8:11], a[92:95], v[236:239], v[8:11]
    ds_read_b64_tr_b16 a[142:143], v217 offset:14336
    v_lshlrev_b32 v17, 4, v17
    v_mfma_f32_16x16x32_bf16 v[8:11], a[96:99], v[236:239], v[8:11]
    ds_read_b64_tr_b16 a[144:145], v217 offset:16384
    v_lshrrev_b32 v18, 2, v16
    v_mfma_f32_16x16x32_bf16 v[8:11], a[100:103], v[236:239], v[8:11]
    ds_read_b64_tr_b16 a[146:147], v217 offset:18432
    ds_read_b64_tr_b16 a[148:149], v217 offset:20480
    v_mfma_f32_16x16x32_bf16 v[8:11], a[104:107], v[236:239], v[8:11]
    ds_read_b64_tr_b16 a[150:151], v217 offset:22528
    ds_read_b64_tr_b16 a[152:153], v217 offset:24576
    v_mfma_f32_16x16x32_bf16 v[8:11], a[108:111], v[236:239], v[8:11]
    ds_read_b64_tr_b16 a[154:155], v217 offset:26624
    ds_read_b64_tr_b16 a[156:157], v217 offset:28672
    v_mfma_f32_16x16x32_bf16 v[8:11], a[112:115], v[236:239], v[8:11]
    ds_read_b64_tr_b16 a[158:159], v217 offset:30720
    ds_read_b64_tr_b16 a[160:161], v217 offset:32768
    v_mfma_f32_16x16x32_bf16 v[8:11], a[116:119], v[236:239], v[8:11]
    ds_read_b64_tr_b16 a[162:163], v217 offset:34816
    ds_read_b64_tr_b16 a[164:165], v217 offset:36864
    v_mfma_f32_16x16x32_bf16 v[8:11], a[120:123], v[236:239], v[8:11]
    ds_read_b64_tr_b16 a[166:167], v217 offset:38912
    ds_read_b64_tr_b16 a[168:169], v217 offset:40960
    v_mfma_f32_16x16x32_bf16 v[8:11], a[124:127], v[236:239], v[8:11]
    ds_read_b64_tr_b16 a[170:171], v217 offset:43008
    ds_read_b64_tr_b16 a[172:173], v217 offset:45056
    ds_read_b64_tr_b16 a[174:175], v217 offset:47104
    v_and_b32 v16, 3, v16
    v_lshl_add_u32 v16, v18, 3, v16
    v_mul_u32_u24 v16, 1024, v16
    v_add_u32 v198, v16, v17
    v_add_u32 v199, 15360, v198
    v_add_u32 v200, 2048, v198
    v_add_u32 v201, 17408, v198
    s_lshl_b32 s92, s33, 15
    s_lshl_b32 s73, s66, 7
    s_add_u32 s92, s92, s73
    s_or_b32 s72, s2, s33
    s_cbranch_scc1 L_ep_8
    v_mov_b32 v16, s95
    v_mov_b32 v17, 0
    s_mov_b64 exec, 1
    global_store_dword v17, v16, s[64:65] offset:1536 sc1
    s_mov_b64 exec, -1
L_ep_8:
    s_bitcmp0_b32 s2, 2
    s_cbranch_scc1 L_nl_9
    v_mov_b32 v219, 0
    s_mov_b64 exec, s[58:59]
    buffer_atomic_add v219, v253, s[8:11], s99 offen sc0 sc1
    s_mov_b64 exec, -1
    s_waitcnt vmcnt(0)
L_nl_9:
    s_mov_b64 s[52:53], -1
    s_mov_b32 s54, s33
    s_sub_u32 s55, s98, 32768
    s_mov_b64 exec, s[58:59]
    s_waitcnt vmcnt(6)
    v_cmp_ne_u32 vcc, 16, v219
    s_nop 0
    s_and_b64 exec, exec, vcc
    s_cbranch_scc1 L_poll_10
L_pollx_11:
    s_mov_b64 exec, -1
    s_add_u32 s99, s99, 32768
    s_waitcnt lgkmcnt(0)
    s_barrier
L_qkv_again_0:
    s_add_u32 m0, s40, 0
    s_add_u32 s94, s39, 0
    buffer_load_dwordx4 v209, s[8:11], s94 offen sc1 lds
    s_add_u32 m0, s40, 4096
    s_add_u32 s94, s39, 4096
    buffer_load_dwordx4 v209, s[8:11], s94 offen sc1 lds
    s_add_u32 m0, s40, 8192
    s_add_u32 s94, s39, 8192
    buffer_load_dwordx4 v209, s[8:11], s94 offen sc1 lds
    s_add_u32 m0, s40, 12288
    s_add_u32 s94, s39, 12288
    buffer_load_dwordx4 v209, s[8:11], s94 offen sc1 lds
    s_add_u32 m0, s32, 16384
    s_add_u32 s89, s37, 16384
    buffer_load_dwordx4 v209, s[8:11], s89 offen offset:0 sc1 lds
    buffer_load_dwordx4 v209, s[8:11], s89 offen offset:1024 sc1 lds
    buffer_load_dwordx4 v209, s[8:11], s89 offen offset:2048 sc1 lds
    buffer_load_dwordx4 v209, s[8:11], s89 offen offset:3072 sc1 lds
    s_add_u32 m0, s32, 32768
    s_add_u32 s89, s37, 32768
    buffer_load_dwordx4 v209, s[8:11], s89 offen offset:0 sc1 lds
    v_mfma_f32_16x16x32_bf16 v[12:15], v[236:239], a[128:131], 0
    v_mfma_f32_16x16x32_bf16 v[12:15], v[236:239], a[132:135], v[12:15]
    v_mfma_f32_16x16x32_bf16 v[12:15], v[236:239], a[136:139], v[12:15]
    v_mfma_f32_16x16x32_bf16 v[12:15], v[236:239], a[140:143], v[12:15]
    v_mfma_f32_16x16x32_bf16 v[12:15], v[236:239], a[144:147], v[12:15]
    v_mfma_f32_16x16x32_bf16 v[12:15], v[236:239], a[148:151], v[12:15]
    v_mfma_f32_16x16x32_bf16 v[12:15], v[236:239], a[152:155], v[12:15]
    v_mfma_f32_16x16x32_bf16 v[12:15], v[236:239], a[156:159], v[12:15]
    v_mfma_f32_16x16x32_bf16 v[12:15], v[236:239], a[160:163], v[12:15]
    v_mfma_f32_16x16x32_bf16 v[12:15], v[236:239], a[164:167], v[12:15]
    v_mfma_f32_16x16x32_bf16 v[12:15], v[236:239], a[168:171], v[12:15]
    v_mfma_f32_16x16x32_bf16 v[12:15], v[236:239], a[172:175], v[12:15]
    s_waitcnt vmcnt(7)
    s_barrier
    ds_read_b64_tr_b16 a[192:193], v207 offset:0
    ds_read_b64_tr_b16 a[194:195], v207 offset:2048
    ds_read_b64_tr_b16 v[146:147], v204 offset:0
    ds_read_b64_tr_b16 v[148:149], v204 offset:2048
    ds_read_b64_tr_b16 v[80:81], v205 offset:0
    ds_read_b64_tr_b16 v[82:83], v205 offset:2048
    ds_read_b64_tr_b16 v[150:151], v208 offset:0
    ds_read_b64_tr_b16 v[152:153], v208 offset:2048
    ds_read_b64_tr_b16 a[196:197], v207 offset:4096
    ds_read_b64_tr_b16 a[198:199], v207 offset:6144
L_warm_0_1:
    s_cbranch_execz L_wret_0
    ds_read_b64_tr_b16 v[154:155], v204 offset:4096
    ds_read_b64_tr_b16 v[156:157], v204 offset:6144
    s_cmp_eq_u32 s52, 0
    s_cbranch_scc1 L_wvo_15
    ds_read_b64_tr_b16 a[176:177], v217 offset:49152
    ds_read_b64_tr_b16 a[178:179], v217 offset:51200
    ds_read_b64_tr_b16 a[180:181], v217 offset:53248
    ds_read_b64_tr_b16 a[182:183], v217 offset:55296
    ds_read_b64_tr_b16 a[184:185], v217 offset:57344
    ds_read_b64_tr_b16 a[186:187], v217 offset:59392
    ds_read_b64_tr_b16 a[188:189], v217 offset:61440
    ds_read_b64_tr_b16 a[190:191], v217 offset:63488
L_wv_14:
    v_mov_b32 v186, 0x3727c5ac
    s_waitcnt lgkmcnt(14)
    v_mfma_f32_16x16x32_bf16 v[44:47], a[64:67], a[192:195], 0
    buffer_load_dwordx4 v209, s[8:11], s89 offen offset:1024 sc1 lds
    v_mfma_f32_16x16x32_bf16 v[60:63], a[192:195], a[128:131], 0
    ds_read_b64_tr_b16 v[84:85], v205 offset:4096
    s_lshl3_add_u32 s93, s60, s92
    v_mfma_f32_16x16x32_bf16 v[32:35], a[64:67], v[146:149], 0
    ds_read_b64_tr_b16 v[86:87], v205 offset:6144
    v_mfma_f32_16x16x32_bf16 v[16:19], a[0:3], v[146:149], 0
    ds_read_b64_tr_b16 v[158:159], v208 offset:4096
    s_waitcnt lgkmcnt(5)
    v_mfma_f32_16x16x32_bf16 v[12:15], v[236:239], a[176:179], v[12:15]
    v_mfma_f32_16x16x32_bf16 v[12:15], v[236:239], a[180:183], v[12:15]
    v_mfma_f32_16x16x32_bf16 v[12:15], v[236:239], a[184:187], v[12:15]
    s_waitcnt lgkmcnt(3)
    v_mfma_f32_16x16x32_bf16 v[12:15], v[236:239], a[188:191], v[12:15]
    v_mfma_f32_16x16x32_bf16 v[48:51], v[146:149], a[128:131], 0
    buffer_load_dwordx4 v209, s[8:11], s89 offen offset:2048 sc1 lds
    v_mfma_f32_16x16x32_bf16 v[36:39], a[64:67], v[80:83], 0
    ds_read_b64_tr_b16 v[160:161], v208 offset:6144
    v_mfma_f32_16x16x32_bf16 v[20:23], a[0:3], v[80:83], 0
    s_waitcnt vmcnt(7)
    s_barrier
    ds_read_b64_tr_b16 a[200:201], v207 offset:8192
    v_mfma_f32_16x16x32_bf16 v[52:55], v[80:83], a[128:131], 0
    ds_read_b64_tr_b16 a[202:203], v207 offset:10240
    v_mfma_f32_16x16x32_bf16 v[64:67], v[150:153], v[150:153], 0
    buffer_load_dwordx4 v209, s[8:11], s89 offen offset:3072 sc1 lds
    v_mfma_f32_16x16x32_bf16 v[68:71], v[236:239], v[150:153], 0
    ds_read_b64_tr_b16 v[162:163], v204 offset:8192
    s_add_u32 m0, s32, 49152
    v_mfma_f32_16x16x32_bf16 v[44:47], a[68:71], a[196:199], v[44:47]
    ds_read_b64_tr_b16 v[164:165], v204 offset:10240
    s_add_u32 s89, s37, 49152
    v_mfma_f32_16x16x32_bf16 v[60:63], a[196:199], a[132:135], v[60:63]
    ds_read_b64_tr_b16 v[166:167], v208 offset:8192
    v_mfma_f32_16x16x32_bf16 v[32:35], a[68:71], v[154:157], v[32:35]
    buffer_load_dwordx4 v209, s[8:11], s89 offen offset:0 sc1 lds
    v_mfma_f32_16x16x32_bf16 v[16:19], a[4:7], v[154:157], v[16:19]
    ds_read_b64_tr_b16 v[168:169], v208 offset:10240
    v_mfma_f32_16x16x32_bf16 v[48:51], v[154:157], a[132:135], v[48:51]
    ds_read_b64_tr_b16 a[204:205], v207 offset:12288
    s_waitcnt lgkmcnt(4)
    v_mfma_f32_16x16x32_bf16 v[36:39], a[68:71], v[84:87], v[36:39]
    ds_read_b64_tr_b16 a[206:207], v207 offset:14336
    v_mfma_f32_16x16x32_bf16 v[20:23], a[4:7], v[84:87], v[20:23]
    buffer_load_dwordx4 v209, s[8:11], s89 offen offset:1024 sc1 lds
    v_mfma_f32_16x16x32_bf16 v[52:55], v[84:87], a[132:135], v[52:55]
    ds_read_b64_tr_b16 v[170:171], v204 offset:12288
    v_mfma_f32_16x16x32_bf16 v[64:67], v[158:161], v[158:161], v[64:67]
    ds_read_b64_tr_b16 v[172:173], v204 offset:14336
    v_mfma_f32_16x16x32_bf16 v[68:71], v[236:239], v[158:161], v[68:71]
    ds_read_b64_tr_b16 v[174:175], v208 offset:12288
    v_mfma_f32_16x16x32_bf16 v[44:47], a[72:75], a[200:203], v[44:47]
    buffer_load_dwordx4 v209, s[8:11], s89 offen offset:2048 sc1 lds
    v_mfma_f32_16x16x32_bf16 v[60:63], a[200:203], a[136:139], v[60:63]
    ds_read_b64_tr_b16 v[176:177], v208 offset:14336
    s_waitcnt lgkmcnt(4)
    v_mfma_f32_16x16x32_bf16 v[32:35], a[72:75], v[162:165], v[32:35]
    s_waitcnt vmcnt(7)
    s_barrier
    ds_read_b64_tr_b16 a[208:209], v207 offset:16384
    v_mfma_f32_16x16x32_bf16 v[16:19], a[8:11], v[162:165], v[16:19]
    ds_read_b64_tr_b16 a[210:211], v207 offset:18432
    v_mfma_f32_16x16x32_bf16 v[48:51], v[162:165], a[136:139], v[48:51]
    buffer_load_dwordx4 v209, s[8:11], s89 offen offset:3072 sc1 lds
    v_mfma_f32_16x16x32_bf16 v[64:67], v[166:169], v[166:169], v[64:67]
    ds_read_b64_tr_b16 v[146:147], v204 offset:16384
    s_add_u32 m0, s60, s88
    v_mfma_f32_16x16x32_bf16 v[68:71], v[236:239], v[166:169], v[68:71]
    ds_read_b64_tr_b16 v[148:149], v204 offset:18432
    v_mfma_f32_16x16x32_bf16 v[44:47], a[76:79], a[204:207], v[44:47]
    v_mfma_f32_16x16x32_bf16 v[60:63], a[204:207], a[140:143], v[60:63]
    ds_read_b64_tr_b16 v[150:151], v208 offset:16384
    s_waitcnt lgkmcnt(3)
    v_mfma_f32_16x16x32_bf16 v[32:35], a[76:79], v[170:173], v[32:35]
    ds_read_b64_tr_b16 v[152:153], v208 offset:18432
    v_mfma_f32_16x16x32_bf16 v[16:19], a[12:15], v[170:173], v[16:19]
    ds_read_b64_tr_b16 a[212:213], v207 offset:20480
    v_mfma_f32_16x16x32_bf16 v[48:51], v[170:173], a[140:143], v[48:51]
    ds_read_b64_tr_b16 a[214:215], v207 offset:22528
    v_mfma_f32_16x16x32_bf16 v[64:67], v[174:177], v[174:177], v[64:67]
    ds_read_b64_tr_b16 v[154:155], v204 offset:20480
    v_mfma_f32_16x16x32_bf16 v[68:71], v[236:239], v[174:177], v[68:71]
    ds_read_b64_tr_b16 v[156:157], v204 offset:22528
    v_mfma_f32_16x16x32_bf16 v[44:47], a[80:83], a[208:211], v[44:47]
    v_mfma_f32_16x16x32_bf16 v[60:63], a[208:211], a[144:147], v[60:63]
    ds_read_b64_tr_b16 v[158:159], v208 offset:20480
    s_waitcnt lgkmcnt(4)
    v_mfma_f32_16x16x32_bf16 v[32:35], a[80:83], v[146:149], v[32:35]
    ds_read_b64_tr_b16 v[160:161], v208 offset:22528
    v_mfma_f32_16x16x32_bf16 v[16:19], a[16:19], v[146:149], v[16:19]
    ds_read_b64_tr_b16 a[216:217], v207 offset:24576
    v_mfma_f32_16x16x32_bf16 v[48:51], v[146:149], a[144:147], v[48:51]
    ds_read_b64_tr_b16 a[218:219], v207 offset:26624
    v_mfma_f32_16x16x32_bf16 v[64:67], v[150:153], v[150:153], v[64:67]
    ds_read_b64_tr_b16 v[162:163], v204 offset:24576
    v_mfma_f32_16x16x32_bf16 v[68:71], v[236:239], v[150:153], v[68:71]
    ds_read_b64_tr_b16 v[164:165], v204 offset:26624
    s_waitcnt lgkmcnt(5)
    v_mfma_f32_16x16x32_bf16 v[44:47], a[84:87], a[212:215], v[44:47]
    v_mfma_f32_16x16x32_bf16 v[60:63], a[212:215], a[148:151], v[60:63]
    ds_read_b64_tr_b16 v[166:167], v208 offset:24576
    v_mfma_f32_16x16x32_bf16 v[32:35], a[84:87], v[154:157], v[32:35]
    ds_read_b64_tr_b16 v[168:169], v208 offset:26624
    v_mfma_f32_16x16x32_bf16 v[16:19], a[20:23], v[154:157], v[16:19]
    ds_read_b64_tr_b16 a[220:221], v207 offset:28672
    v_mfma_f32_16x16x32_bf16 v[48:51], v[154:157], a[148:151], v[48:51]
    ds_read_b64_tr_b16 a[222:223], v207 offset:30720
    s_waitcnt lgkmcnt(4)
    v_mfma_f32_16x16x32_bf16 v[64:67], v[158:161], v[158:161], v[64:67]
    ds_read_b64_tr_b16 v[170:171], v204 offset:28672
    v_mfma_f32_16x16x32_bf16 v[68:71], v[236:239], v[158:161], v[68:71]
    ds_read_b64_tr_b16 v[172:173], v204 offset:30720
    v_mfma_f32_16x16x32_bf16 v[44:47], a[88:91], a[216:219], v[44:47]
    ds_read_b64_tr_b16 v[174:175], v208 offset:28672
    v_mfma_f32_16x16x32_bf16 v[60:63], a[216:219], a[152:155], v[60:63]
    ds_read_b64_tr_b16 v[176:177], v208 offset:30720
    v_mfma_f32_16x16x32_bf16 v[32:35], a[88:91], v[162:165], v[32:35]
    s_waitcnt vmcnt(4)
    s_barrier
    ds_read_b64_tr_b16 v[146:147], v208 offset:32768
    v_mfma_f32_16x16x32_bf16 v[16:19], a[24:27], v[162:165], v[16:19]
    ds_read_b64_tr_b16 v[148:149], v208 offset:34816
    v_mfma_f32_16x16x32_bf16 v[48:51], v[162:165], a[152:155], v[48:51]
    ds_read_b64_tr_b16 v[150:151], v208 offset:36864
    s_waitcnt lgkmcnt(5)
    v_mfma_f32_16x16x32_bf16 v[64:67], v[166:169], v[166:169], v[64:67]
    ds_read_b64_tr_b16 v[152:153], v208 offset:38912
    v_mfma_f32_16x16x32_bf16 v[68:71], v[236:239], v[166:169], v[68:71]
    ds_read_b64_tr_b16 a[224:225], v207 offset:32768
    v_mfma_f32_16x16x32_bf16 v[44:47], a[92:95], a[220:223], v[44:47]
    ds_read_b64_tr_b16 a[226:227], v207 offset:34816
    v_mfma_f32_16x16x32_bf16 v[60:63], a[220:223], a[156:159], v[60:63]
    ds_read_b64_tr_b16 v[154:155], v204 offset:32768
    v_mfma_f32_16x16x32_bf16 v[32:35], a[92:95], v[170:173], v[32:35]
    ds_read_b64_tr_b16 v[156:157], v204 offset:34816
    v_mfma_f32_16x16x32_bf16 v[16:19], a[28:31], v[170:173], v[16:19]
    ds_read_b64_tr_b16 v[158:159], v208 offset:40960
    v_mfma_f32_16x16x32_bf16 v[48:51], v[170:173], a[156:159], v[48:51]
    ds_read_b64_tr_b16 v[160:161], v208 offset:43008
    s_waitcnt lgkmcnt(5)
    v_mfma_f32_16x16x32_bf16 v[64:67], v[174:177], v[174:177], v[64:67]
    ds_read_b64_tr_b16 v[162:163], v208 offset:45056
    v_mfma_f32_16x16x32_bf16 v[68:71], v[236:239], v[174:177], v[68:71]
    ds_read_b64_tr_b16 v[164:165], v208 offset:47104
    v_mfma_f32_16x16x32_bf16 v[64:67], v[146:149], v[146:149], v[64:67]
    ds_read_b64_tr_b16 a[228:229], v207 offset:36864
    v_mfma_f32_16x16x32_bf16 v[68:71], v[236:239], v[146:149], v[68:71]
    ds_read_b64_tr_b16 a[230:231], v207 offset:38912
    v_mfma_f32_16x16x32_bf16 v[64:67], v[150:153], v[150:153], v[64:67]
    ds_read_b64_tr_b16 v[166:167], v204 offset:36864
    v_mfma_f32_16x16x32_bf16 v[68:71], v[236:239], v[150:153], v[68:71]
    ds_read_b64_tr_b16 v[168:169], v204 offset:38912
    s_waitcnt lgkmcnt(5)
    v_mfma_f32_16x16x32_bf16 v[44:47], a[96:99], a[224:227], v[44:47]
    s_waitcnt vmcnt(0)
    s_barrier
    ds_read_b64_tr_b16 v[170:171], v208 offset:49152
    s_cmp_lg_u32 s54, 0
    s_cbranch_scc1 L_nh_16
    v_mov_b32 v203, 1
    s_mov_b64 exec, 1
    buffer_atomic_add v203, v253, s[8:11], s55 offen offset:4 sc1
    s_mov_b64 exec, -1
L_nh_16:
    v_mfma_f32_16x16x32_bf16 v[60:63], a[224:227], a[160:163], v[60:63]
    ds_read_b64_tr_b16 v[172:173], v208 offset:51200
    v_mfma_f32_16x16x32_bf16 v[32:35], a[96:99], v[154:157], v[32:35]
    ds_read_b64_tr_b16 v[174:175], v208 offset:53248
    v_mfma_f32_16x16x32_bf16 v[16:19], a[32:35], v[154:157], v[16:19]
    ds_read_b64_tr_b16 v[176:177], v208 offset:55296
    v_mfma_f32_16x16x32_bf16 v[48:51], v[154:157], a[160:163], v[48:51]
    ds_read_b64_tr_b16 a[232:233], v207 offset:40960
    v_mfma_f32_16x16x32_bf16 v[64:67], v[158:161], v[158:161], v[64:67]
    ds_read_b64_tr_b16 a[234:235], v207 offset:43008
    ds_read_b64_tr_b16 v[146:147], v208 offset:57344
    v_mfma_f32_16x16x32_bf16 v[68:71], v[236:239], v[158:161], v[68:71]
    s_mov_b64 exec, 1
    buffer_load_dword v254, v253, s[8:11], s43 offen sc1
    s_mov_b64 exec, -1
    s_waitcnt lgkmcnt(5)
    v_mfma_f32_16x16x32_bf16 v[64:67], v[162:165], v[162:165], v[64:67]
    ds_read_b64_tr_b16 v[148:149], v208 offset:59392
    v_mfma_f32_16x16x32_bf16 v[68:71], v[236:239], v[162:165], v[68:71]
    ds_read_b64_tr_b16 v[150:151], v208 offset:61440
    v_mfma_f32_16x16x32_bf16 v[44:47], a[100:103], a[228:231], v[44:47]
    ds_read_b64_tr_b16 v[152:153], v208 offset:63488
    ds_read_b64_tr_b16 a[236:237], v207 offset:45056
    v_mfma_f32_16x16x32_bf16 v[60:63], a[228:231], a[164:167], v[60:63]
    buffer_load_dwordx4 v198, s[20:23], s93 offen offset:0 lds
    v_mfma_f32_16x16x32_bf16 v[32:35], a[100:103], v[166:169], v[32:35]
    ds_read_b64_tr_b16 a[238:239], v207 offset:47104
    v_mfma_f32_16x16x32_bf16 v[16:19], a[36:39], v[166:169], v[16:19]
    ds_read_b64_tr_b16 a[240:241], v207 offset:49152
    v_mfma_f32_16x16x32_bf16 v[48:51], v[166:169], a[164:167], v[48:51]
    ds_read_b64_tr_b16 a[242:243], v207 offset:51200
    ds_read_b64_tr_b16 a[244:245], v207 offset:53248
    v_mfma_f32_16x16x32_bf16 v[64:67], v[170:173], v[170:173], v[64:67]
    buffer_load_dwordx4 v199, s[20:23], s93 offen offset:1024 lds
    v_mfma_f32_16x16x32_bf16 v[68:71], v[236:239], v[170:173], v[68:71]
    ds_read_b64_tr_b16 a[246:247], v207 offset:55296
    s_waitcnt lgkmcnt(5)
    v_mfma_f32_16x16x32_bf16 v[64:67], v[174:177], v[174:177], v[64:67]
    ds_read_b64_tr_b16 a[248:249], v207 offset:57344
    v_mfma_f32_16x16x32_bf16 v[68:71], v[236:239], v[174:177], v[68:71]
    ds_read_b64_tr_b16 a[250:251], v207 offset:59392
    ds_read_b64_tr_b16 a[252:253], v207 offset:61440
    v_mfma_f32_16x16x32_bf16 v[44:47], a[104:107], a[232:235], v[44:47]
    buffer_load_dwordx4 v200, s[20:23], s93 offen offset:2048 lds
    v_mfma_f32_16x16x32_bf16 v[60:63], a[232:235], a[168:171], v[60:63]
    ds_read_b64_tr_b16 a[254:255], v207 offset:63488
    v_mfma_f32_16x16x32_bf16 v[64:67], v[146:149], v[146:149], v[64:67]
    ds_read_b64_tr_b16 v[88:89], v204 offset:40960
    v_mfma_f32_16x16x32_bf16 v[68:71], v[236:239], v[146:149], v[68:71]
    ds_read_b64_tr_b16 v[90:91], v204 offset:43008
    ds_read_b64_tr_b16 v[92:93], v204 offset:45056
    v_mfma_f32_16x16x32_bf16 v[64:67], v[150:153], v[150:153], v[64:67]
    buffer_load_dwordx4 v201, s[20:23], s93 offen offset:3072 lds
    v_mfma_f32_16x16x32_bf16 v[68:71], v[236:239], v[150:153], v[68:71]
    ds_read_b64_tr_b16 v[94:95], v204 offset:47104
    ds_read_b64_tr_b16 v[96:97], v204 offset:49152
    s_waitcnt lgkmcnt(6)
    v_mfma_f32_16x16x32_bf16 v[44:47], a[108:111], a[236:239], v[44:47]
    ds_read_b64_tr_b16 v[98:99], v204 offset:51200
    s_add_u32 m0, s61, s88
    v_cndmask_b32 v180, v64, v65, s[84:85]
    v_cndmask_b32 v180, v180, v66, s[12:13]
    v_cndmask_b32 v180, v180, v67, s[14:15]
    v_cndmask_b32 v181, 0, v180, s[28:29]
    v_cndmask_b32 v180, 0, v180, s[28:29]
    v_mul_f32 v182, 0x3b000000, v68
    v_fma_f32 v184, -v182, v182, v186
    v_permlane32_swap_b32 v180, v181
    v_add_f32 v183, v180, v181
    v_add_f32 v181, v180, v181
    v_mfma_f32_16x16x32_bf16 v[60:63], a[236:239], a[172:175], v[60:63]
    ds_read_b64_tr_b16 v[100:101], v204 offset:53248
    ds_read_b64_tr_b16 v[102:103], v204 offset:55296
    v_permlane16_swap_b32 v183, v181
    v_add_f32 v180, v183, v181
    v_fmamk_f32 v180, v180, 0x3b000000, v184
    v_max_f32 v180, v180, v186
    v_rsq_f32 v180, v180
    v_mfma_f32_16x16x32_bf16 v[44:47], a[112:115], a[240:243], v[44:47]
    s_lshl3_add_u32 s93, s61, s92
    buffer_load_dwordx4 v198, s[20:23], s93 offen offset:0 lds
    ds_write2_b32 v216, v180, v182 offset0:0 offset1:64
    v_mfma_f32_16x16x32_bf16 v[60:63], a[240:243], a[176:179], v[60:63]
    ds_read_b64_tr_b16 v[104:105], v204 offset:57344
    v_mfma_f32_16x16x32_bf16 v[44:47], a[116:119], a[244:247], v[44:47]
    ds_read_b64_tr_b16 v[106:107], v204 offset:59392
    v_mfma_f32_16x16x32_bf16 v[60:63], a[244:247], a[180:183], v[60:63]
    ds_read_b64_tr_b16 v[108:109], v204 offset:61440
    v_mfma_f32_16x16x32_bf16 v[44:47], a[120:123], a[248:251], v[44:47]
    buffer_load_dwordx4 v199, s[20:23], s93 offen offset:1024 lds
    v_mfma_f32_16x16x32_bf16 v[60:63], a[248:251], a[184:187], v[60:63]
    ds_read_b64_tr_b16 v[110:111], v204 offset:63488
    s_waitcnt lgkmcnt(5)
    v_mfma_f32_16x16x32_bf16 v[44:47], a[124:127], a[252:255], v[44:47]
    ds_read_b64_tr_b16 v[80:81], v205 offset:8192
    v_mfma_f32_16x16x32_bf16 v[60:63], a[252:255], a[188:191], v[60:63]
    ds_read_b64_tr_b16 v[82:83], v205 offset:10240
    v_mfma_f32_16x16x32_bf16 v[32:35], a[104:107], v[88:91], v[32:35]
    buffer_load_dwordx4 v200, s[20:23], s93 offen offset:2048 lds
    v_mfma_f32_16x16x32_bf16 v[16:19], a[40:43], v[88:91], v[16:19]
    s_waitcnt lgkmcnt(6)
    s_barrier
    ds_read2_b32 v[144:145], v214 offset0:48 offset1:112
    ds_read2_b32 v[138:139], v214 offset0:0 offset1:64
    ds_read2_b32 v[142:143], v214 offset0:32 offset1:96
    ds_read2_b32 v[140:141], v214 offset0:16 offset1:80
    v_mfma_f32_16x16x32_bf16 v[48:51], v[88:91], a[168:171], v[48:51]
    ds_read_b64_tr_b16 v[84:85], v205 offset:12288
    ds_read_b128 v[174:177], v215 offset:448
    v_mfma_f32_16x16x32_bf16 v[32:35], a[108:111], v[92:95], v[32:35]
    ds_read_b64_tr_b16 v[86:87], v205 offset:14336
    ds_read_b128 v[170:173], v215 offset:192
    v_mfma_f32_16x16x32_bf16 v[16:19], a[44:47], v[92:95], v[16:19]
    buffer_load_dwordx4 v201, s[20:23], s93 offen offset:3072 lds
    v_mfma_f32_16x16x32_bf16 v[48:51], v[92:95], a[172:175], v[48:51]
    ds_read_b64_tr_b16 v[88:89], v205 offset:16384
    s_add_u32 m0, s62, s88
    v_mfma_f32_16x16x32_bf16 v[32:35], a[112:115], v[96:99], v[32:35]
    ds_read_b64_tr_b16 v[90:91], v205 offset:18432
    s_lshl3_add_u32 s93, s62, s92
    v_mfma_f32_16x16x32_bf16 v[16:19], a[48:51], v[96:99], v[16:19]
    ds_read_b64_tr_b16 v[92:93], v205 offset:20480
    ds_read_b128 v[166:169], v215 offset:384
    v_mfma_f32_16x16x32_bf16 v[48:51], v[96:99], a[176:179], v[48:51]
    buffer_load_dwordx4 v198, s[20:23], s93 offen offset:0 lds
    v_mfma_f32_16x16x32_bf16 v[32:35], a[116:119], v[100:103], v[32:35]
    ds_read_b64_tr_b16 v[94:95], v205 offset:22528
    ds_read_b128 v[162:165], v215 offset:128
    v_mfma_f32_16x16x32_bf16 v[16:19], a[52:55], v[100:103], v[16:19]
    ds_read_b64_tr_b16 v[96:97], v205 offset:24576
    ds_read_b128 v[150:153], v215 offset:256
    v_mfma_f32_16x16x32_bf16 v[48:51], v[100:103], a[180:183], v[48:51]
    ds_read_b64_tr_b16 v[98:99], v205 offset:26624
    s_waitcnt lgkmcnt(7)
    v_mfma_f32_16x16x32_bf16 v[32:35], a[120:123], v[104:107], v[32:35]
    buffer_load_dwordx4 v199, s[20:23], s93 offen offset:1024 lds
    v_mfma_f32_16x16x32_bf16 v[16:19], a[56:59], v[104:107], v[16:19]
    v_cmp_u_f32 s[90:91], v145, v139
    v_cmp_u_f32 s[76:77], v143, v141
    v_mfma_f32_16x16x32_bf16 v[48:51], v[104:107], a[184:187], v[48:51]
    ds_read_b64_tr_b16 v[100:101], v205 offset:28672
    s_or_b64 s[90:91], s[90:91], s[76:77]
    v_mfma_f32_16x16x32_bf16 v[32:35], a[124:127], v[108:111], v[32:35]
    ds_read_b64_tr_b16 v[102:103], v205 offset:30720
    v_fma_f32 v44, -v145, v8, v44
    v_mfma_f32_16x16x32_bf16 v[16:19], a[60:63], v[108:111], v[16:19]
    buffer_load_dwordx4 v200, s[20:23], s93 offen offset:2048 lds
    v_mfma_f32_16x16x32_bf16 v[48:51], v[108:111], a[188:191], v[48:51]
    ds_read_b64_tr_b16 v[104:105], v205 offset:32768
    v_fma_f32 v45, -v145, v9, v45
    v_mfma_f32_16x16x32_bf16 v[36:39], a[72:75], v[80:83], v[36:39]
    ds_read_b64_tr_b16 v[106:107], v205 offset:34816
    v_fma_f32 v46, -v145, v10, v46
    v_mfma_f32_16x16x32_bf16 v[20:23], a[8:11], v[80:83], v[20:23]
    ds_read_b64_tr_b16 v[108:109], v205 offset:36864
    v_fma_f32 v47, -v145, v11, v47
    v_mfma_f32_16x16x32_bf16 v[52:55], v[80:83], a[136:139], v[52:55]
    buffer_load_dwordx4 v201, s[20:23], s93 offen offset:3072 lds
    v_mfma_f32_16x16x32_bf16 v[36:39], a[76:79], v[84:87], v[36:39]
    ds_read_b64_tr_b16 v[110:111], v205 offset:38912
    s_add_u32 m0, s63, s88
    v_mfma_f32_16x16x32_bf16 v[20:23], a[12:15], v[84:87], v[20:23]
    ds_read_b64_tr_b16 v[80:81], v205 offset:40960
    s_lshl3_add_u32 s93, s63, s92
    v_mfma_f32_16x16x32_bf16 v[52:55], v[84:87], a[140:143], v[52:55]
    ds_read_b64_tr_b16 v[82:83], v205 offset:43008
    v_fma_f32 v60, -v174, v12, v60
    v_mfma_f32_16x16x32_bf16 v[36:39], a[80:83], v[88:91], v[36:39]
    buffer_load_dwordx4 v198, s[20:23], s93 offen offset:0 lds
    v_mfma_f32_16x16x32_bf16 v[20:23], a[16:19], v[88:91], v[20:23]
    s_and_b64 vcc, s[90:91], s[52:53]
    s_cbranch_scc1 L_qkv_redo_0
    v_mfma_f32_16x16x32_bf16 v[52:55], v[88:91], a[144:147], v[52:55]
    ds_read_b64_tr_b16 v[84:85], v205 offset:45056
    s_waitcnt lgkmcnt(3)
    v_mfma_f32_16x16x32_bf16 v[36:39], a[84:87], v[92:95], v[36:39]
    ds_read_b64_tr_b16 v[86:87], v205 offset:47104
    v_fma_f32 v61, -v175, v12, v61
    v_mfma_f32_16x16x32_bf16 v[20:23], a[20:23], v[92:95], v[20:23]
    buffer_load_dwordx4 v199, s[20:23], s93 offen offset:1024 lds
    v_mfma_f32_16x16x32_bf16 v[52:55], v[92:95], a[148:151], v[52:55]
    ds_read_b64_tr_b16 v[88:89], v205 offset:49152
    v_fma_f32 v62, -v176, v12, v62
    v_mfma_f32_16x16x32_bf16 v[36:39], a[88:91], v[96:99], v[36:39]
    ds_read_b64_tr_b16 v[90:91], v205 offset:51200
    v_fma_f32 v63, -v177, v12, v63
    v_mfma_f32_16x16x32_bf16 v[20:23], a[24:27], v[96:99], v[20:23]
    ds_read_b64_tr_b16 v[92:93], v205 offset:53248
    v_mul_f32 v44, v44, v144
    v_mfma_f32_16x16x32_bf16 v[52:55], v[96:99], a[152:155], v[52:55]
    buffer_load_dwordx4 v200, s[20:23], s93 offen offset:2048 lds
    v_mfma_f32_16x16x32_bf16 v[36:39], a[92:95], v[100:103], v[36:39]
    ds_read_b64_tr_b16 v[94:95], v205 offset:55296
    v_mul_f32 v45, v45, v144
    v_mfma_f32_16x16x32_bf16 v[20:23], a[28:31], v[100:103], v[20:23]
    ds_read_b64_tr_b16 v[96:97], v205 offset:57344
    v_mul_f32 v46, v46, v144
    v_mfma_f32_16x16x32_bf16 v[52:55], v[100:103], a[156:159], v[52:55]
    ds_read_b64_tr_b16 v[98:99], v205 offset:59392
    v_mul_f32 v47, v47, v144
    v_mfma_f32_16x16x32_bf16 v[36:39], a[96:99], v[104:107], v[36:39]
    buffer_load_dwordx4 v201, s[20:23], s93 offen offset:3072 lds
    v_mfma_f32_16x16x32_bf16 v[20:23], a[32:35], v[104:107], v[20:23]
    v_cvt_pk_bf16_f32 v134, v44, v45
    v_cvt_pk_bf16_f32 v135, v46, v47
    v_mfma_f32_16x16x32_bf16 v[52:55], v[104:107], a[160:163], v[52:55]
    ds_read_b64_tr_b16 v[100:101], v205 offset:61440
    v_mul_f32 v60, v60, v170
    v_mfma_f32_16x16x32_bf16 v[36:39], a[100:103], v[108:111], v[36:39]
    ds_read_b64_tr_b16 v[102:103], v205 offset:63488
    v_mul_f32 v61, v61, v171
    v_mfma_f32_16x16x32_bf16 v[20:23], a[36:39], v[108:111], v[20:23]
    v_mul_f32 v62, v62, v172
    v_mul_f32 v63, v63, v173
    v_mfma_f32_16x16x32_bf16 v[52:55], v[108:111], a[164:167], v[52:55]
    v_cvt_pk_bf16_f32 v136, v60, v61
    s_waitcnt lgkmcnt(2)
    v_mfma_f32_16x16x32_bf16 v[36:39], a[104:107], v[80:83], v[36:39]
    v_cvt_pk_bf16_f32 v137, v62, v63
    buffer_store_dwordx4 v[134:137], v211, s[8:11], s71 offen sc1
    v_mfma_f32_16x16x32_bf16 v[20:23], a[40:43], v[80:83], v[20:23]
    v_cvt_pk_bf16_f32 v132, v60, v61
    v_cvt_pk_bf16_f32 v133, v62, v63
    v_mfma_f32_16x16x32_bf16 v[52:55], v[80:83], a[168:171], v[52:55]
    ds_read_b128 v[146:149], v215 offset:0
    ds_read_b128 v[158:161], v215 offset:320
    v_mfma_f32_16x16x32_bf16 v[36:39], a[108:111], v[84:87], v[36:39]
    ds_read_b128 v[154:157], v215 offset:64
    v_mul_f32 v28, -v145, v4
    v_mfma_f32_16x16x32_bf16 v[20:23], a[44:47], v[84:87], v[20:23]
    v_mul_f32 v29, -v145, v5
    v_mul_f32 v30, -v145, v6
    v_mfma_f32_16x16x32_bf16 v[52:55], v[84:87], a[172:175], v[52:55]
    v_mul_f32 v31, -v145, v7
    v_mul_f32 v40, -v143, v8
    v_mfma_f32_16x16x32_bf16 v[36:39], a[112:115], v[88:91], v[36:39]
    v_mul_f32 v41, -v143, v9
    v_mul_f32 v42, -v143, v10
    v_mfma_f32_16x16x32_bf16 v[20:23], a[48:51], v[88:91], v[20:23]
    v_mul_f32 v43, -v143, v11
    v_mul_f32 v24, -v143, v4
    v_mfma_f32_16x16x32_bf16 v[52:55], v[88:91], a[176:179], v[52:55]
    v_mul_f32 v25, -v143, v5
    v_mul_f32 v26, -v143, v6
    v_mfma_f32_16x16x32_bf16 v[36:39], a[116:119], v[92:95], v[36:39]
    v_mul_f32 v27, -v143, v7
    v_mul_f32 v56, -v166, v12
    v_mfma_f32_16x16x32_bf16 v[20:23], a[52:55], v[92:95], v[20:23]
    v_mul_f32 v57, -v167, v12
    v_mul_f32 v58, -v168, v12
    v_mfma_f32_16x16x32_bf16 v[52:55], v[92:95], a[180:183], v[52:55]
    v_mul_f32 v59, -v169, v12
    v_fma_f32 v32, -v139, v8, v32
    v_mfma_f32_16x16x32_bf16 v[36:39], a[120:123], v[96:99], v[36:39]
    v_fma_f32 v33, -v139, v9, v33
    v_fma_f32 v34, -v139, v10, v34
    v_mfma_f32_16x16x32_bf16 v[20:23], a[56:59], v[96:99], v[20:23]
    v_fma_f32 v35, -v139, v11, v35
    v_fma_f32 v48, -v150, v12, v48
    v_mfma_f32_16x16x32_bf16 v[52:55], v[96:99], a[184:187], v[52:55]
    v_fma_f32 v49, -v151, v12, v49
    s_waitcnt lgkmcnt(0)
    v_mfma_f32_16x16x32_bf16 v[36:39], a[124:127], v[100:103], v[36:39]
    v_fma_f32 v50, -v152, v12, v50
    v_fma_f32 v51, -v153, v12, v51
    v_mfma_f32_16x16x32_bf16 v[20:23], a[60:63], v[100:103], v[20:23]
    v_fma_f32 v16, -v139, v4, v16
    v_fma_f32 v17, -v139, v5, v17
    v_mfma_f32_16x16x32_bf16 v[52:55], v[100:103], a[188:191], v[52:55]
    v_fma_f32 v18, -v139, v6, v18
    v_fma_f32 v19, -v139, v7, v19
    v_mfma_f32_16x16x32_bf16 v[28:31], a[0:3], a[192:195], v[28:31]
    v_mul_f32 v32, v32, v138
    v_mul_f32 v33, v33, v138
    v_mfma_f32_16x16x32_bf16 v[28:31], a[4:7], a[196:199], v[28:31]
    ds_read_b64_tr_b16 a[192:193], v206 offset:0
    v_mul_f32 v34, v34, v138
    v_mfma_f32_16x16x32_bf16 v[28:31], a[8:11], a[200:203], v[28:31]
    ds_read_b64_tr_b16 a[194:195], v206 offset:2048
    v_mul_f32 v35, v35, v138
    v_mfma_f32_16x16x32_bf16 v[28:31], a[12:15], a[204:207], v[28:31]
    ds_read_b64_tr_b16 a[196:197], v206 offset:4096
    v_cvt_pk_bf16_f32 v116, v32, v33
    v_mfma_f32_16x16x32_bf16 v[28:31], a[16:19], a[208:211], v[28:31]
    ds_read_b64_tr_b16 a[198:199], v206 offset:6144
    v_cvt_pk_bf16_f32 v117, v34, v35
    v_mfma_f32_16x16x32_bf16 v[28:31], a[20:23], a[212:215], v[28:31]
    ds_read_b64_tr_b16 a[200:201], v206 offset:8192
    v_mul_f32 v48, v48, v146
    v_mfma_f32_16x16x32_bf16 v[28:31], a[24:27], a[216:219], v[28:31]
    ds_read_b64_tr_b16 a[202:203], v206 offset:10240
    v_mul_f32 v49, v49, v147
    v_mfma_f32_16x16x32_bf16 v[28:31], a[28:31], a[220:223], v[28:31]
    ds_read_b64_tr_b16 a[204:205], v206 offset:12288
    v_mul_f32 v50, v50, v148
    v_mfma_f32_16x16x32_bf16 v[28:31], a[32:35], a[224:227], v[28:31]
    ds_read_b64_tr_b16 a[206:207], v206 offset:14336
    v_mul_f32 v51, v51, v149
    v_mfma_f32_16x16x32_bf16 v[28:31], a[36:39], a[228:231], v[28:31]
    ds_read_b64_tr_b16 a[208:209], v206 offset:16384
    v_cvt_pk_bf16_f32 v126, v48, v49
    v_mfma_f32_16x16x32_bf16 v[28:31], a[40:43], a[232:235], v[28:31]
    ds_read_b64_tr_b16 a[210:211], v206 offset:18432
    v_cvt_pk_bf16_f32 v127, v50, v51
    v_mfma_f32_16x16x32_bf16 v[28:31], a[44:47], a[236:239], v[28:31]
    ds_read_b64_tr_b16 a[212:213], v206 offset:20480
    v_fma_f32 v36, -v141, v8, v36
    v_mfma_f32_16x16x32_bf16 v[28:31], a[48:51], a[240:243], v[28:31]
    ds_read_b64_tr_b16 a[214:215], v206 offset:22528
    v_fma_f32 v37, -v141, v9, v37
    v_mfma_f32_16x16x32_bf16 v[28:31], a[52:55], a[244:247], v[28:31]
    ds_read_b64_tr_b16 a[216:217], v206 offset:24576
    v_fma_f32 v38, -v141, v10, v38
    v_mfma_f32_16x16x32_bf16 v[28:31], a[56:59], a[248:251], v[28:31]
    ds_read_b64_tr_b16 a[218:219], v206 offset:26624
    v_fma_f32 v39, -v141, v11, v39
    v_mfma_f32_16x16x32_bf16 v[28:31], a[60:63], a[252:255], v[28:31]
    ds_read_b64_tr_b16 a[220:221], v206 offset:28672
    s_waitcnt lgkmcnt(5)
    v_mfma_f32_16x16x32_bf16 v[40:43], a[64:67], a[192:195], v[40:43]
    ds_read_b64_tr_b16 a[222:223], v206 offset:30720
    s_waitcnt vmcnt(1)
    s_barrier
    v_mfma_f32_16x16x32_bf16 v[24:27], a[0:3], a[192:195], v[24:27]
    ds_read_b64_tr_b16 a[224:225], v206 offset:32768
    v_fma_f32 v20, -v141, v4, v20
    v_mfma_f32_16x16x32_bf16 v[40:43], a[68:71], a[196:199], v[40:43]
    ds_read_b64_tr_b16 a[226:227], v206 offset:34816
    v_fma_f32 v21, -v141, v5, v21
    v_mfma_f32_16x16x32_bf16 v[24:27], a[4:7], a[196:199], v[24:27]
    ds_read_b64_tr_b16 a[228:229], v206 offset:36864
    v_fma_f32 v22, -v141, v6, v22
    v_mfma_f32_16x16x32_bf16 v[40:43], a[72:75], a[200:203], v[40:43]
    ds_read_b64_tr_b16 a[230:231], v206 offset:38912
    v_fma_f32 v23, -v141, v7, v23
    v_mfma_f32_16x16x32_bf16 v[24:27], a[8:11], a[200:203], v[24:27]
    ds_read_b64_tr_b16 a[232:233], v206 offset:40960
    v_fma_f32 v52, -v158, v12, v52
    v_mfma_f32_16x16x32_bf16 v[40:43], a[76:79], a[204:207], v[40:43]
    buffer_load_dwordx4 v[122:125], v210, s[8:11], s38 offen sc1
    v_mfma_f32_16x16x32_bf16 v[24:27], a[12:15], a[204:207], v[24:27]
    ds_read_b64_tr_b16 a[234:235], v206 offset:43008
    v_fma_f32 v53, -v159, v12, v53
    v_mfma_f32_16x16x32_bf16 v[40:43], a[80:83], a[208:211], v[40:43]
    ds_read_b64_tr_b16 a[236:237], v206 offset:45056
    v_fma_f32 v54, -v160, v12, v54
    v_mfma_f32_16x16x32_bf16 v[24:27], a[16:19], a[208:211], v[24:27]
    ds_read_b64_tr_b16 a[238:239], v206 offset:47104
    s_waitcnt lgkmcnt(4)
    v_mfma_f32_16x16x32_bf16 v[40:43], a[84:87], a[212:215], v[40:43]
    ds_read_b64_tr_b16 a[240:241], v206 offset:49152
    v_fma_f32 v55, -v161, v12, v55
    v_mfma_f32_16x16x32_bf16 v[24:27], a[20:23], a[212:215], v[24:27]
    ds_read_b64_tr_b16 a[242:243], v206 offset:51200
    v_mul_f32 v36, v36, v140
    v_mfma_f32_16x16x32_bf16 v[40:43], a[88:91], a[216:219], v[40:43]
    ds_read_b64_tr_b16 a[244:245], v206 offset:53248
    v_mul_f32 v37, v37, v140
    v_mfma_f32_16x16x32_bf16 v[24:27], a[24:27], a[216:219], v[24:27]
    ds_read_b64_tr_b16 a[246:247], v206 offset:55296
    v_mul_f32 v38, v38, v140
    v_mfma_f32_16x16x32_bf16 v[40:43], a[92:95], a[220:223], v[40:43]
    ds_read_b64_tr_b16 a[248:249], v206 offset:57344
    v_mul_f32 v39, v39, v140
    v_mfma_f32_16x16x32_bf16 v[24:27], a[28:31], a[220:223], v[24:27]
    ds_read_b64_tr_b16 a[250:251], v206 offset:59392
    v_cvt_pk_bf16_f32 v118, v36, v37
    v_mfma_f32_16x16x32_bf16 v[40:43], a[96:99], a[224:227], v[40:43]
    ds_read_b64_tr_b16 a[252:253], v206 offset:61440
    v_cvt_pk_bf16_f32 v119, v38, v39
    v_mfma_f32_16x16x32_bf16 v[24:27], a[32:35], a[224:227], v[24:27]
    ds_read_b64_tr_b16 a[254:255], v206 offset:63488
    v_mul_f32 v52, v52, v154
    v_mfma_f32_16x16x32_bf16 v[40:43], a[100:103], a[228:231], v[40:43]
    v_mul_f32 v53, v53, v155
L_warm_0_2:
    s_cbranch_execz L_wret_0
    v_mul_f32 v54, v54, v156
    v_mfma_f32_16x16x32_bf16 v[24:27], a[36:39], a[228:231], v[24:27]
    v_mul_f32 v55, v55, v157
    s_waitcnt lgkmcnt(3)
    v_mfma_f32_16x16x32_bf16 v[40:43], a[104:107], a[232:235], v[40:43]
    v_cvt_pk_bf16_f32 v128, v52, v53
    v_cvt_pk_bf16_f32 v129, v54, v55
    v_mfma_f32_16x16x32_bf16 v[24:27], a[40:43], a[232:235], v[24:27]
    v_cvt_pk_bf16_f32 v112, v20, v21
    v_cvt_pk_bf16_f32 v113, v22, v23
    v_mfma_f32_16x16x32_bf16 v[40:43], a[108:111], a[236:239], v[40:43]
    v_mul_f32 v182, 0x3eb8aa3b, v140
    v_cvt_pk_bf16_f32 v90, v28, v29
    v_mfma_f32_16x16x16_bf16 v[20:23], v[118:119], v[112:113], v[220:223]
    v_cvt_pk_bf16_f32 v91, v30, v31
    v_mul_f32 v96, 0x3eb8aa3b, v142
    v_mfma_f32_16x16x16_bf16 v[36:39], v[116:117], v[112:113], v[224:227]
    v_mul_f32 v84, 0x3eb8aa3b, v144
    v_cvt_pk_bf16_f32 v114, v16, v17
    v_mfma_f32_16x16x16_bf16 v[28:31], v[134:135], v[90:91], v[220:223]
    v_cvt_pk_bf16_f32 v115, v18, v19
    v_mul_f32 v192, 0x3eb8aa3b, v138
    v_mfma_f32_16x16x32_bf16 v[24:27], a[44:47], a[236:239], v[24:27]
    v_max_f32 v178, v20, v21
    v_max_f32 v179, v22, v23
    v_mfma_f32_16x16x16_bf16 v[16:19], v[116:117], v[114:115], v[220:223]
    v_max3_f32 v178, v178, v36, v37
    v_max3_f32 v179, v179, v38, v39
    v_mfma_f32_16x16x32_bf16 v[40:43], a[112:115], a[240:243], v[40:43]
    v_max_f32 v180, v178, v179
    v_max_f32 v181, v178, v179
    v_mfma_f32_16x16x32_bf16 v[24:27], a[48:51], a[240:243], v[24:27]
    v_max_f32 v80, v28, v29
    v_max_f32 v81, v30, v31
    v_mfma_f32_16x16x32_bf16 v[40:43], a[116:119], a[244:247], v[40:43]
    v_permlane32_swap_b32 v180, v181
    v_mfma_f32_16x16x32_bf16 v[24:27], a[52:55], a[244:247], v[24:27]
    v_max_f32 v183, v180, v181
    s_waitcnt lgkmcnt(0)
    v_mfma_f32_16x16x32_bf16 v[40:43], a[120:123], a[248:251], v[40:43]
    v_max_f32 v181, v180, v181
    v_max_f32 v188, v16, v17
    v_mfma_f32_16x16x32_bf16 v[24:27], a[56:59], a[248:251], v[24:27]
    v_permlane16_swap_b32 v183, v181
    v_mfma_f32_16x16x32_bf16 v[40:43], a[124:127], a[252:255], v[40:43]
    v_max_f32 v180, v183, v181
    v_mul_f32 v180, v180, v182
    v_mfma_f32_16x16x32_bf16 v[24:27], a[60:63], a[252:255], v[24:27]
    v_fma_f32 v178, v178, v182, -v180
    v_fma_f32 v179, v179, v182, -v180
    v_mfma_f32_16x16x32_bf16 v[56:59], a[192:195], a[128:131], v[56:59]
    v_exp_f32 v178, v178
    v_mfma_f32_16x16x32_bf16 v[56:59], a[196:199], a[132:135], v[56:59]
    v_exp_f32 v179, v179
    v_mfma_f32_16x16x32_bf16 v[56:59], a[200:203], a[136:139], v[56:59]
    v_cvt_pk_bf16_f32 v178, v178, v179
    v_perm_b32 v184, v178, v178, v232
    v_mfma_f32_16x16x32_bf16 v[56:59], a[204:207], a[140:143], v[56:59]
    v_perm_b32 v185, v178, v178, v233
    v_perm_b32 v186, v178, v178, v234
    v_mfma_f32_16x16x32_bf16 v[56:59], a[208:211], a[144:147], v[56:59]
    v_perm_b32 v187, v178, v178, v235
    v_mul_f32 v40, v40, v142
    v_mfma_f32_16x16x32_bf16 v[56:59], a[212:215], a[148:151], v[56:59]
    v_mul_f32 v41, v41, v142
    v_mul_f32 v42, v42, v142
    v_mfma_f32_16x16x32_bf16 v[36:39], v[236:239], v[184:187], 0
    v_mul_f32 v43, v43, v142
    v_cvt_pk_bf16_f32 v120, v40, v41
    v_mfma_f32_16x16x32_bf16 v[20:23], v[126:129], v[184:187], 0
    v_cvt_pk_bf16_f32 v121, v42, v43
    v_cvt_pk_bf16_f32 v102, v24, v25
    v_mfma_f32_16x16x32_bf16 v[56:59], a[216:219], a[152:155], v[56:59]
    v_cvt_pk_bf16_f32 v103, v26, v27
    v_max_f32 v189, v18, v19
    v_mfma_f32_16x16x16_bf16 v[44:47], v[120:121], v[90:91], v[224:227]
    v_rcp_f32 v36, v36
    v_mfma_f32_16x16x16_bf16 v[24:27], v[120:121], v[102:103], v[220:223]
    v_mul_f32 v20, v20, v36
    v_mul_f32 v21, v21, v36
    v_mfma_f32_16x16x16_bf16 v[40:43], v[118:119], v[102:103], v[224:227]
    v_mul_f32 v22, v22, v36
    v_mul_f32 v23, v23, v36
    v_mfma_f32_16x16x32_bf16 v[56:59], a[220:223], a[156:159], v[56:59]
    v_cvt_pk_bf16_f32 v72, v20, v21
    v_cvt_pk_bf16_f32 v73, v22, v23
    v_mfma_f32_16x16x32_bf16 v[56:59], a[224:227], a[160:163], v[56:59]
    v_max_f32 v92, v24, v25
    v_max_f32 v93, v26, v27
    v_mfma_f32_16x16x32_bf16 v[56:59], a[228:231], a[164:167], v[56:59]
    v_max3_f32 v92, v92, v40, v41
    v_max3_f32 v80, v80, v44, v45
    v_mfma_f32_16x16x32_bf16 v[56:59], a[232:235], a[168:171], v[56:59]
    v_max3_f32 v93, v93, v42, v43
    v_max3_f32 v81, v81, v46, v47
    v_mfma_f32_16x16x32_bf16 v[56:59], a[236:239], a[172:175], v[56:59]
    v_max_f32 v94, v92, v93
    v_max_f32 v82, v80, v81
    v_mfma_f32_16x16x32_bf16 v[56:59], a[240:243], a[176:179], v[56:59]
    s_waitcnt vmcnt(0)
    v_max3_u32 v202, v122, v123, v124
    v_mfma_f32_16x16x32_bf16 v[56:59], a[244:247], a[180:183], v[56:59]
    v_max_u32 v202, v202, v125
    v_mfma_f32_16x16x32_bf16 v[56:59], a[248:251], a[184:187], v[56:59]
    v_cmp_eq_u32 vcc, -1, v202
    s_nop 0
    s_or_b64 vcc, vcc, vcc
    s_cbranch_scc1 L_hx_12
L_hxb_13:
    v_mfma_f32_16x16x16_bf16 v[32:35], v[122:123], v[114:115], v[228:231]
    v_permlane32_swap_b32 v94, v82
    v_mfma_f32_16x16x32_bf16 v[56:59], a[252:255], a[188:191], v[56:59]
    v_max_f32 v95, v94, v82
    v_max_f32 v83, v94, v82
    s_nop 3
    v_max3_f32 v188, v188, v32, v33
    v_max3_f32 v189, v189, v34, v35
    v_max_f32 v190, v188, v189
    v_max_f32 v191, v188, v189
    v_permlane16_swap_b32 v95, v83
    v_max_f32 v94, v95, v83
    v_permlane32_swap_b32 v190, v191
    v_max_f32 v193, v190, v191
    v_max_f32 v191, v190, v191
    v_max_f32 v82, v95, v83
    v_pk_mul_f32 v[56:57], v[56:57], v[162:163]
    v_permlane16_swap_b32 v193, v191
    v_max_f32 v190, v193, v191
    v_permlane32_swap_b32 v94, v82
    v_mul_f32 v94, v94, v96
    v_mul_f32 v82, v82, v84
    v_mul_f32 v190, v190, v192
    v_fma_f32 v92, v92, v96, -v94
    v_fma_f32 v80, v80, v84, -v82
    v_fma_f32 v188, v188, v192, -v190
    v_fma_f32 v93, v93, v96, -v94
    v_fma_f32 v81, v81, v84, -v82
    v_fma_f32 v189, v189, v192, -v190
    v_exp_f32 v92, v92
    v_exp_f32 v80, v80
    v_exp_f32 v188, v188
    v_exp_f32 v93, v93
    v_exp_f32 v81, v81
    v_exp_f32 v189, v189
    v_cvt_pk_bf16_f32 v92, v92, v93
    v_cvt_pk_bf16_f32 v80, v80, v81
    v_cvt_pk_bf16_f32 v188, v188, v189
    v_perm_b32 v98, v92, v92, v232
    v_perm_b32 v86, v80, v80, v232
    v_perm_b32 v194, v188, v188, v232
    v_perm_b32 v99, v92, v92, v233
    v_perm_b32 v87, v80, v80, v233
    v_perm_b32 v195, v188, v188, v233
    v_perm_b32 v100, v92, v92, v234
    v_perm_b32 v88, v80, v80, v234
    v_perm_b32 v196, v188, v188, v234
    v_perm_b32 v101, v92, v92, v235
    v_perm_b32 v89, v80, v80, v235
    v_perm_b32 v197, v188, v188, v235
    v_mfma_f32_16x16x32_bf16 v[40:43], v[236:239], v[98:101], 0
    v_mfma_f32_16x16x32_bf16 v[44:47], v[236:239], v[86:89], 0
    v_mfma_f32_16x16x32_bf16 v[32:35], v[236:239], v[194:197], 0
    v_pk_mul_f32 v[58:59], v[58:59], v[164:165]
    v_mfma_f32_16x16x32_bf16 v[16:19], v[124:127], v[194:197], 0
    v_cvt_pk_bf16_f32 v130, v56, v57
    v_cvt_pk_bf16_f32 v131, v58, v59
    s_nop 1
    v_mfma_f32_16x16x32_bf16 v[24:27], v[128:131], v[98:101], 0
    v_mfma_f32_16x16x32_bf16 v[28:31], v[130:133], v[86:89], 0
    v_rcp_f32 v40, v40
    v_rcp_f32 v44, v44
    v_rcp_f32 v32, v32
    s_nop 3
    v_pk_mul_f32 v[24:25], v[24:25], v[40:41] op_sel:[0,0] op_sel_hi:[1,0]
    v_pk_mul_f32 v[28:29], v[28:29], v[44:45] op_sel:[0,0] op_sel_hi:[1,0]
    v_pk_mul_f32 v[16:17], v[16:17], v[32:33] op_sel:[0,0] op_sel_hi:[1,0]
    v_pk_mul_f32 v[26:27], v[26:27], v[40:41] op_sel:[0,0] op_sel_hi:[1,0]
    v_pk_mul_f32 v[30:31], v[30:31], v[44:45] op_sel:[0,0] op_sel_hi:[1,0]
    v_pk_mul_f32 v[18:19], v[18:19], v[32:33] op_sel:[0,0] op_sel_hi:[1,0]
    v_cvt_pk_bf16_f32 v74, v24, v25
    v_cvt_pk_bf16_f32 v78, v28, v29
    v_cvt_pk_bf16_f32 v76, v16, v17
    v_cvt_pk_bf16_f32 v75, v26, v27
    v_cvt_pk_bf16_f32 v79, v30, v31
    v_cvt_pk_bf16_f32 v77, v18, v19
    v_permlane16_swap_b32 v72, v74
    v_permlane16_swap_b32 v73, v75
    s_cmp_lg_u32 s101, 0
    s_cbranch_scc1 L_sg_17
    buffer_store_dwordx4 v[72:75], v212, s[8:11], s42 offen
L_sb_18:
    v_permlane16_swap_b32 v76, v78
    v_permlane16_swap_b32 v77, v79
    s_cmp_lg_u32 s101, 0
    s_cbranch_scc1 L_sg_19
    buffer_store_dwordx4 v[76:79], v213, s[8:11], s41 offen
L_sb_20:
    v_add_u32 v196, 98304, v204
    v_add_u32 v197, 98304, v205
    v_add_u32 v198, 98304, v206
    v_add_u32 v199, 98304, v207
    s_lshl2_add_u32 s72, s66, s33
    s_lshl1_add_u32 s72, s72, s43
    v_mov_b32 v203, 1
    v_lshlrev_b32 v201, 2, v1
    ds_read_b64_tr_b16 a[192:193], v196 offset:0
    ds_read_b64_tr_b16 a[194:195], v196 offset:2048
    ds_read_b64_tr_b16 a[196:197], v197 offset:0
    ds_read_b64_tr_b16 a[198:199], v197 offset:2048
    ds_read_b64_tr_b16 a[200:201], v198 offset:0
    ds_read_b64_tr_b16 a[202:203], v198 offset:2048
    ds_read_b64_tr_b16 a[204:205], v199 offset:0
    ds_read_b64_tr_b16 a[206:207], v199 offset:2048
    ds_read_b64_tr_b16 a[208:209], v196 offset:4096
    ds_read_b64_tr_b16 a[210:211], v196 offset:6144
    ds_read_b64_tr_b16 a[212:213], v197 offset:4096
    ds_read_b64_tr_b16 a[214:215], v197 offset:6144
    ds_read_b64_tr_b16 a[216:217], v198 offset:4096
    ds_read_b64_tr_b16 a[218:219], v198 offset:6144
    ds_read_b64_tr_b16 a[220:221], v199 offset:4096
    ds_read_b64_tr_b16 a[222:223], v199 offset:6144
    ds_read_b64_tr_b16 a[224:225], v196 offset:8192
    ds_read_b64_tr_b16 a[226:227], v196 offset:10240
    ds_read_b64_tr_b16 a[228:229], v197 offset:8192
    ds_read_b64_tr_b16 a[230:231], v197 offset:10240
    s_waitcnt vmcnt(0)
    s_mov_b64 exec, 1
    s_cmp_lg_u32 s101, 0
    s_cbranch_scc1 L_sg_21
    buffer_store_short v203, v253, s[8:11], s72 offen
L_sb_22:
    s_mov_b64 exec, -1
    v_bfe_u32 v200, v2, 1, 2
    v_xor_b32 v200, s33, v200
    v_lshlrev_b32 v200, 5, v200
    v_lshl_add_u32 v200, v2, 7, v200
    v_lshl_add_u32 v200, v3, 3, v200
    v_add_u32 v200, s50, v200
    ds_read_b64 v[32:33], v200 offset:0
    ds_read_b64 v[34:35], v200 offset:2048
    ds_read_b64 v[36:37], v200 offset:4096
    ds_read_b64 v[38:39], v200 offset:6144
    s_add_u32 s45, s44, 32896
    s_add_u32 s46, s44, 65792
    s_add_u32 s47, s44, 98688
    s_mov_b64 exec, 0xffff
    buffer_load_dword v203, v201, s[8:11], s43 offen sc1
    s_mov_b64 exec, -1
    ds_read_b64_tr_b16 a[232:233], v198 offset:8192
    ds_read_b64_tr_b16 a[234:235], v198 offset:10240
    ds_read_b64_tr_b16 a[236:237], v199 offset:8192
    ds_read_b64_tr_b16 a[238:239], v199 offset:10240
    ds_read_b64_tr_b16 a[240:241], v196 offset:12288
    ds_read_b64_tr_b16 a[242:243], v196 offset:14336
    ds_read_b64_tr_b16 a[244:245], v197 offset:12288
    ds_read_b64_tr_b16 a[246:247], v197 offset:14336
    ds_read_b64_tr_b16 a[248:249], v198 offset:12288
    ds_read_b64_tr_b16 a[250:251], v198 offset:14336
    ds_read_b64_tr_b16 a[252:253], v199 offset:12288
    ds_read_b64_tr_b16 a[254:255], v199 offset:14336
    ds_read_b64_tr_b16 v[104:105], v196 offset:16384
    ds_read_b64_tr_b16 v[106:107], v196 offset:18432
    ds_read_b64_tr_b16 v[108:109], v197 offset:16384
    ds_read_b64_tr_b16 v[110:111], v197 offset:18432
    s_waitcnt lgkmcnt(15)
    v_lshlrev_b32 v16, 16, v32
    v_and_b32 v17, 0xffff0000, v32
    v_lshlrev_b32 v18, 16, v33
    v_and_b32 v19, 0xffff0000, v33
    v_lshlrev_b32 v20, 16, v34
    v_and_b32 v21, 0xffff0000, v34
    v_lshlrev_b32 v22, 16, v35
    v_and_b32 v23, 0xffff0000, v35
    v_lshlrev_b32 v24, 16, v36
    v_and_b32 v25, 0xffff0000, v36
    v_lshlrev_b32 v26, 16, v37
    v_and_b32 v27, 0xffff0000, v37
    v_lshlrev_b32 v28, 16, v38
    v_and_b32 v29, 0xffff0000, v38
    v_lshlrev_b32 v30, 16, v39
    v_and_b32 v31, 0xffff0000, v39
    s_mov_b64 exec, 0xffff
    s_mov_b32 s80, 0
    s_mov_b32 s73, 0x10001
    s_waitcnt vmcnt(0)
L_lp_23:
    v_cmp_ne_u32 vcc, s73, v203
    s_nop 0
    s_and_b64 exec, exec, vcc
    s_cbranch_scc0 L_lpx_24
    buffer_load_dword v203, v201, s[8:11], s43 offen sc1
    s_add_u32 s80, s80, 1
    s_cmp_lt_u32 s80, 400000
    s_waitcnt vmcnt(0)
    s_cbranch_scc1 L_lp_23
L_lpx_24:
    s_mov_b64 exec, -1
    buffer_load_dwordx4 v[40:43], v211, s[8:11], s44 offen offset:0 sc1
    buffer_load_dwordx4 v[44:47], v211, s[8:11], s44 offen offset:1024 sc1
    buffer_load_dwordx4 v[48:51], v211, s[8:11], s44 offen offset:2048 sc1
    buffer_load_dwordx4 v[52:55], v211, s[8:11], s44 offen offset:3072 sc1
    buffer_load_dwordx4 v[56:59], v211, s[8:11], s45 offen offset:0 sc1
    buffer_load_dwordx4 v[60:63], v211, s[8:11], s45 offen offset:1024 sc1
    ds_read_b64_tr_b16 v[112:113], v198 offset:16384
    ds_read_b64_tr_b16 v[114:115], v198 offset:18432
    ds_read_b64_tr_b16 v[116:117], v199 offset:16384
    ds_read_b64_tr_b16 v[118:119], v199 offset:18432
    ds_read_b64_tr_b16 v[120:121], v196 offset:20480
    ds_read_b64_tr_b16 v[122:123], v196 offset:22528
    ds_read_b64_tr_b16 v[124:125], v197 offset:20480
    ds_read_b64_tr_b16 v[126:127], v197 offset:22528
    ds_read_b64_tr_b16 v[128:129], v198 offset:20480
    ds_read_b64_tr_b16 v[130:131], v198 offset:22528
    ds_read_b64_tr_b16 v[132:133], v199 offset:20480
    ds_read_b64_tr_b16 v[134:135], v199 offset:22528
    ds_read_b64_tr_b16 v[136:137], v196 offset:24576
    ds_read_b64_tr_b16 v[138:139], v196 offset:26624
    ds_read_b64_tr_b16 v[140:141], v197 offset:24576
    ds_read_b64_tr_b16 v[142:143], v197 offset:26624
    v_lshrrev_b32 v200, 1, v2
    v_lshlrev_b32 v200, 7, v200
    v_lshl_add_u32 v200, v3, 4, v200
    v_and_b32 v201, 1, v2
    v_lshl_add_u32 v200, v201, 3, v200
    v_cmp_eq_u32 s[90:91], 1, v201
    v_and_b32 v203, 60, v1
    v_lshl_add_u32 v201, v201, 13, v203
    s_add_u32 s41, s41, s100
    s_add_u32 s42, s42, s100
    s_add_u32 s37, s37, 7602176
    s_add_u32 s39, s39, 7602176
    s_add_u32 s38, s38, 1572864
    s_add_u32 s71, s71, 1572864
    s_waitcnt vmcnt(5)
    v_mfma_f32_16x16x32_bf16 v[16:19], v[40:43], a[192:195], v[16:19]
    ds_read_b64_tr_b16 v[144:145], v198 offset:24576
    v_mfma_f32_16x16x32_bf16 v[20:23], v[40:43], a[196:199], v[20:23]
    buffer_load_dwordx4 v[64:67], v211, s[8:11], s45 offen offset:2048 sc1
    v_mfma_f32_16x16x32_bf16 v[24:27], v[40:43], a[200:203], v[24:27]
    ds_read_b64_tr_b16 v[146:147], v198 offset:26624
    v_mfma_f32_16x16x32_bf16 v[28:31], v[40:43], a[204:207], v[28:31]
    ds_read_b64_tr_b16 v[148:149], v199 offset:24576
    s_waitcnt vmcnt(5)
    v_mfma_f32_16x16x32_bf16 v[16:19], v[44:47], a[208:211], v[16:19]
    ds_read_b64_tr_b16 v[150:151], v199 offset:26624
    v_mfma_f32_16x16x32_bf16 v[20:23], v[44:47], a[212:215], v[20:23]
    buffer_load_dwordx4 v[68:71], v211, s[8:11], s45 offen offset:3072 sc1
    v_mfma_f32_16x16x32_bf16 v[24:27], v[44:47], a[216:219], v[24:27]
    ds_read_b64_tr_b16 v[152:153], v196 offset:28672
    v_mfma_f32_16x16x32_bf16 v[28:31], v[44:47], a[220:223], v[28:31]
    ds_read_b64_tr_b16 v[154:155], v196 offset:30720
    s_waitcnt vmcnt(5)
    v_mfma_f32_16x16x32_bf16 v[16:19], v[48:51], a[224:227], v[16:19]
    ds_read_b64_tr_b16 v[156:157], v197 offset:28672
    v_mfma_f32_16x16x32_bf16 v[20:23], v[48:51], a[228:231], v[20:23]
    buffer_load_dwordx4 v[72:75], v211, s[8:11], s46 offen offset:0 sc1
    s_waitcnt lgkmcnt(3)
    v_mfma_f32_16x16x32_bf16 v[24:27], v[48:51], a[232:235], v[24:27]
    ds_read_b64_tr_b16 v[158:159], v197 offset:30720
    ds_read_b64_tr_b16 v[160:161], v198 offset:28672
    v_mfma_f32_16x16x32_bf16 v[28:31], v[48:51], a[236:239], v[28:31]
    ds_read_b64_tr_b16 v[162:163], v198 offset:30720
    ds_read_b64_tr_b16 v[164:165], v199 offset:28672
    s_waitcnt vmcnt(5)
    v_mfma_f32_16x16x32_bf16 v[16:19], v[52:55], a[240:243], v[16:19]
    ds_read_b64_tr_b16 v[166:167], v199 offset:30720
    ds_read_b64_tr_b16 v[168:169], v196 offset:32768
    v_mfma_f32_16x16x32_bf16 v[20:23], v[52:55], a[244:247], v[20:23]
    buffer_load_dwordx4 v[76:79], v211, s[8:11], s46 offen offset:1024 sc1
    v_mfma_f32_16x16x32_bf16 v[24:27], v[52:55], a[248:251], v[24:27]
    ds_read_b64_tr_b16 v[170:171], v196 offset:34816
    ds_read_b64_tr_b16 v[172:173], v197 offset:32768
    v_mfma_f32_16x16x32_bf16 v[28:31], v[52:55], a[252:255], v[28:31]
    ds_read_b64_tr_b16 v[174:175], v197 offset:34816
    ds_read_b64_tr_b16 v[176:177], v198 offset:32768
    s_waitcnt vmcnt(5)
    v_mfma_f32_16x16x32_bf16 v[16:19], v[56:59], v[104:107], v[16:19]
    ds_read_b64_tr_b16 v[178:179], v198 offset:34816
    ds_read_b64_tr_b16 v[180:181], v199 offset:32768
    v_mfma_f32_16x16x32_bf16 v[20:23], v[56:59], v[108:111], v[20:23]
    buffer_load_dwordx4 v[80:83], v211, s[8:11], s46 offen offset:2048 sc1
    v_mfma_f32_16x16x32_bf16 v[24:27], v[56:59], v[112:115], v[24:27]
    ds_read_b64_tr_b16 v[182:183], v199 offset:34816
    ds_read_b64_tr_b16 v[184:185], v196 offset:36864
    v_mfma_f32_16x16x32_bf16 v[28:31], v[56:59], v[116:119], v[28:31]
    ds_read_b64_tr_b16 v[186:187], v196 offset:38912
    ds_read_b64_tr_b16 v[188:189], v197 offset:36864
    s_waitcnt vmcnt(5)
    v_mfma_f32_16x16x32_bf16 v[16:19], v[60:63], v[120:123], v[16:19]
    ds_read_b64_tr_b16 v[190:191], v197 offset:38912
    ds_read_b64_tr_b16 v[192:193], v198 offset:36864
    v_mfma_f32_16x16x32_bf16 v[20:23], v[60:63], v[124:127], v[20:23]
    buffer_load_dwordx4 v[84:87], v211, s[8:11], s46 offen offset:3072 sc1
    v_mfma_f32_16x16x32_bf16 v[24:27], v[60:63], v[128:131], v[24:27]
    ds_read_b64_tr_b16 v[194:195], v198 offset:38912
    ds_read_b64_tr_b16 a[192:193], v199 offset:36864
    v_mfma_f32_16x16x32_bf16 v[28:31], v[60:63], v[132:135], v[28:31]
    ds_read_b64_tr_b16 a[194:195], v199 offset:38912
    ds_read_b64_tr_b16 a[196:197], v196 offset:40960
    s_waitcnt vmcnt(5)
    v_mfma_f32_16x16x32_bf16 v[16:19], v[64:67], v[136:139], v[16:19]
    ds_read_b64_tr_b16 a[198:199], v196 offset:43008
    ds_read_b64_tr_b16 a[200:201], v197 offset:40960
    v_mfma_f32_16x16x32_bf16 v[20:23], v[64:67], v[140:143], v[20:23]
    buffer_load_dwordx4 v[88:91], v211, s[8:11], s47 offen offset:0 sc1
    v_mfma_f32_16x16x32_bf16 v[24:27], v[64:67], v[144:147], v[24:27]
    ds_read_b64_tr_b16 a[202:203], v197 offset:43008
    ds_read_b64_tr_b16 a[204:205], v198 offset:40960
    v_mfma_f32_16x16x32_bf16 v[28:31], v[64:67], v[148:151], v[28:31]
    ds_read_b64_tr_b16 a[206:207], v198 offset:43008
    ds_read_b64_tr_b16 a[208:209], v199 offset:40960
    s_waitcnt vmcnt(5) lgkmcnt(8)
    v_mfma_f32_16x16x32_bf16 v[16:19], v[68:71], v[152:155], v[16:19]
    ds_read_b64_tr_b16 a[210:211], v199 offset:43008
    ds_read_b64_tr_b16 a[212:213], v196 offset:45056
    v_mfma_f32_16x16x32_bf16 v[20:23], v[68:71], v[156:159], v[20:23]
    buffer_load_dwordx4 v[92:95], v211, s[8:11], s47 offen offset:1024 sc1
    v_mfma_f32_16x16x32_bf16 v[24:27], v[68:71], v[160:163], v[24:27]
    ds_read_b64_tr_b16 a[214:215], v196 offset:47104
    ds_read_b64_tr_b16 a[216:217], v197 offset:45056
    v_mfma_f32_16x16x32_bf16 v[28:31], v[68:71], v[164:167], v[28:31]
    ds_read_b64_tr_b16 a[218:219], v197 offset:47104
    ds_read_b64_tr_b16 a[220:221], v198 offset:45056
    s_waitcnt vmcnt(5)
    v_mfma_f32_16x16x32_bf16 v[16:19], v[72:75], v[168:171], v[16:19]
    ds_read_b64_tr_b16 a[222:223], v198 offset:47104
    ds_read_b64_tr_b16 a[224:225], v199 offset:45056
    v_mfma_f32_16x16x32_bf16 v[20:23], v[72:75], v[172:175], v[20:23]
    buffer_load_dwordx4 v[96:99], v211, s[8:11], s47 offen offset:2048 sc1
    v_mfma_f32_16x16x32_bf16 v[24:27], v[72:75], v[176:179], v[24:27]
    ds_read_b64_tr_b16 a[226:227], v199 offset:47104
    ds_read_b64_tr_b16 a[228:229], v196 offset:49152
    v_mfma_f32_16x16x32_bf16 v[28:31], v[72:75], v[180:183], v[28:31]
    ds_read_b64_tr_b16 a[230:231], v196 offset:51200
    ds_read_b64_tr_b16 a[232:233], v197 offset:49152
    s_waitcnt vmcnt(5)
    v_mfma_f32_16x16x32_bf16 v[16:19], v[76:79], v[184:187], v[16:19]
    ds_read_b64_tr_b16 a[234:235], v197 offset:51200
    ds_read_b64_tr_b16 a[236:237], v198 offset:49152
    v_mfma_f32_16x16x32_bf16 v[20:23], v[76:79], v[188:191], v[20:23]
    buffer_load_dwordx4 v[100:103], v211, s[8:11], s47 offen offset:3072 sc1
    v_mfma_f32_16x16x32_bf16 v[24:27], v[76:79], v[192:195], v[24:27]
    ds_read_b64_tr_b16 a[238:239], v198 offset:51200
    ds_read_b64_tr_b16 a[240:241], v199 offset:49152
    s_waitcnt lgkmcnt(8)
    v_mfma_f32_16x16x32_bf16 v[28:31], v[76:79], a[192:195], v[28:31]
    ds_read_b64_tr_b16 a[242:243], v199 offset:51200
    ds_read_b64_tr_b16 a[244:245], v196 offset:53248
    s_waitcnt vmcnt(5)
    v_mfma_f32_16x16x32_bf16 v[16:19], v[80:83], a[196:199], v[16:19]
    ds_read_b64_tr_b16 a[246:247], v196 offset:55296
    ds_read_b64_tr_b16 a[248:249], v197 offset:53248
    v_mfma_f32_16x16x32_bf16 v[20:23], v[80:83], a[200:203], v[20:23]
    ds_read_b64_tr_b16 a[250:251], v197 offset:55296
    ds_read_b64_tr_b16 a[252:253], v198 offset:53248
    v_mfma_f32_16x16x32_bf16 v[24:27], v[80:83], a[204:207], v[24:27]
    ds_read_b64_tr_b16 a[254:255], v198 offset:55296
    ds_read_b64_tr_b16 v[104:105], v199 offset:53248
    v_mfma_f32_16x16x32_bf16 v[28:31], v[80:83], a[208:211], v[28:31]
    ds_read_b64_tr_b16 v[106:107], v199 offset:55296
    ds_read_b64_tr_b16 v[108:109], v196 offset:57344
    s_waitcnt vmcnt(4)
    v_mfma_f32_16x16x32_bf16 v[16:19], v[84:87], a[212:215], v[16:19]
    ds_read_b64_tr_b16 v[110:111], v196 offset:59392
    ds_read_b64_tr_b16 v[112:113], v197 offset:57344
    v_mfma_f32_16x16x32_bf16 v[20:23], v[84:87], a[216:219], v[20:23]
    ds_read_b64_tr_b16 v[114:115], v197 offset:59392
    ds_read_b64_tr_b16 v[116:117], v198 offset:57344
    v_mfma_f32_16x16x32_bf16 v[24:27], v[84:87], a[220:223], v[24:27]
    ds_read_b64_tr_b16 v[118:119], v198 offset:59392
    ds_read_b64_tr_b16 v[120:121], v199 offset:57344
    s_waitcnt lgkmcnt(9)
    v_mfma_f32_16x16x32_bf16 v[28:31], v[84:87], a[224:227], v[28:31]
    ds_read_b64_tr_b16 v[122:123], v199 offset:59392
    ds_read_b64_tr_b16 v[124:125], v196 offset:61440
    s_waitcnt vmcnt(3)
    v_mfma_f32_16x16x32_bf16 v[16:19], v[88:91], a[228:231], v[16:19]
    ds_read_b64_tr_b16 v[126:127], v196 offset:63488
    ds_read_b64_tr_b16 v[128:129], v197 offset:61440
    v_mfma_f32_16x16x32_bf16 v[20:23], v[88:91], a[232:235], v[20:23]
    ds_read_b64_tr_b16 v[130:131], v197 offset:63488
    ds_read_b64_tr_b16 v[132:133], v198 offset:61440
    v_mfma_f32_16x16x32_bf16 v[24:27], v[88:91], a[236:239], v[24:27]
    ds_read_b64_tr_b16 v[134:135], v198 offset:63488
    ds_read_b64_tr_b16 v[136:137], v199 offset:61440
    v_mfma_f32_16x16x32_bf16 v[28:31], v[88:91], a[240:243], v[28:31]
    ds_read_b64_tr_b16 v[138:139], v199 offset:63488
    s_waitcnt vmcnt(2)
    v_mfma_f32_16x16x32_bf16 v[16:19], v[92:95], a[244:247], v[16:19]
    v_mfma_f32_16x16x32_bf16 v[20:23], v[92:95], a[248:251], v[20:23]
    v_mfma_f32_16x16x32_bf16 v[24:27], v[92:95], a[252:255], v[24:27]
    s_waitcnt lgkmcnt(4)
    v_mfma_f32_16x16x32_bf16 v[28:31], v[92:95], v[104:107], v[28:31]
    s_waitcnt vmcnt(1)
    v_mfma_f32_16x16x32_bf16 v[16:19], v[96:99], v[108:111], v[16:19]
    v_mfma_f32_16x16x32_bf16 v[20:23], v[96:99], v[112:115], v[20:23]
    v_mfma_f32_16x16x32_bf16 v[24:27], v[96:99], v[116:119], v[24:27]
    v_mfma_f32_16x16x32_bf16 v[28:31], v[96:99], v[120:123], v[28:31]
    s_waitcnt vmcnt(0)
    v_mfma_f32_16x16x32_bf16 v[16:19], v[100:103], v[124:127], v[16:19]
    v_mfma_f32_16x16x32_bf16 v[20:23], v[100:103], v[128:131], v[20:23]
    s_waitcnt lgkmcnt(0)
    v_mfma_f32_16x16x32_bf16 v[24:27], v[100:103], v[132:135], v[24:27]
    v_mfma_f32_16x16x32_bf16 v[28:31], v[100:103], v[136:139], v[28:31]
    s_nop 3
    v_cvt_pk_bf16_f32 v32, v16, v17
    v_cvt_pk_bf16_f32 v33, v18, v19
    buffer_store_dwordx2 v[32:33], v200, s[8:11], s48 offen offset:0 sc1
    v_cvt_pk_bf16_f32 v34, v20, v21
    v_cvt_pk_bf16_f32 v35, v22, v23
    buffer_store_dwordx2 v[34:35], v200, s[8:11], s48 offen offset:1024 sc1
    v_pk_add_f32 v[40:41], v[16:17], v[20:21]
    v_pk_mul_f32 v[44:45], v[16:17], v[16:17]
    v_pk_add_f32 v[42:43], v[18:19], v[22:23]
    v_pk_mul_f32 v[46:47], v[18:19], v[18:19]
    v_pk_fma_f32 v[44:45], v[20:21], v[20:21], v[44:45]
    v_pk_fma_f32 v[46:47], v[22:23], v[22:23], v[46:47]
    v_pk_add_f32 v[40:41], v[40:41], v[24:25]
    v_pk_fma_f32 v[44:45], v[24:25], v[24:25], v[44:45]
    v_pk_add_f32 v[42:43], v[42:43], v[26:27]
    v_pk_fma_f32 v[46:47], v[26:27], v[26:27], v[46:47]
    v_pk_add_f32 v[40:41], v[40:41], v[28:29]
    v_pk_fma_f32 v[44:45], v[28:29], v[28:29], v[44:45]
    v_pk_add_f32 v[42:43], v[42:43], v[30:31]
    v_pk_fma_f32 v[46:47], v[30:31], v[30:31], v[46:47]
    v_add_f32_dpp v48, v40, v40 row_ror:8 row_mask:0xf bank_mask:0x3
    v_add_f32_dpp v49, v41, v41 row_ror:8 row_mask:0xf bank_mask:0x3
    v_add_f32_dpp v50, v44, v44 row_ror:8 row_mask:0xf bank_mask:0x3
    v_add_f32_dpp v51, v45, v45 row_ror:8 row_mask:0xf bank_mask:0x3
    v_add_f32_dpp v48, v42, v42 row_ror:8 row_mask:0xf bank_mask:0xc
    v_add_f32_dpp v49, v43, v43 row_ror:8 row_mask:0xf bank_mask:0xc
    v_add_f32_dpp v50, v46, v46 row_ror:8 row_mask:0xf bank_mask:0xc
    v_add_f32_dpp v51, v47, v47 row_ror:8 row_mask:0xf bank_mask:0xc
    v_add_f32_dpp v52, v48, v48 row_half_mirror row_mask:0xf bank_mask:0x5
    v_add_f32_dpp v53, v50, v50 row_half_mirror row_mask:0xf bank_mask:0x5
    s_nop 0
    v_add_f32_dpp v52, v49, v49 row_half_mirror row_mask:0xf bank_mask:0xa
    v_add_f32_dpp v53, v51, v51 row_half_mirror row_mask:0xf bank_mask:0xa
    s_nop 0
    v_add_f32_dpp v52, v52, v52 quad_perm:[1,0,3,2] row_mask:0xf bank_mask:0xf
    v_add_f32_dpp v53, v53, v53 quad_perm:[1,0,3,2] row_mask:0xf bank_mask:0xf
    v_cndmask_b32 v52, v52, v53, s[90:91]
    s_nop 1
    v_add_f32_dpp v52, v52, v52 quad_perm:[2,3,0,1] row_mask:0xf bank_mask:0xf
    s_mov_b32 exec_lo, 0x33333333
    s_mov_b32 exec_hi, 0x33333333
    buffer_atomic_add_f32 v52, v201, s[8:11], s49 offen sc1
    s_mov_b64 exec, -1
    v_cvt_pk_bf16_f32 v36, v24, v25
    v_cvt_pk_bf16_f32 v37, v26, v27
    buffer_store_dwordx2 v[36:37], v200, s[8:11], s48 offen offset:2048 sc1
    v_cvt_pk_bf16_f32 v38, v28, v29
    v_cvt_pk_bf16_f32 v39, v30, v31
    buffer_store_dwordx2 v[38:39], v200, s[8:11], s48 offen offset:3072 sc1
    s_add_u32 s44, s44, s100
    s_add_u32 s43, s43, 4096
    v_mov_b32 v196, -1
    v_mov_b32 v197, -1
    v_mov_b32 v198, -1
    v_mov_b32 v199, -1
    s_mov_b64 exec, 0
    s_cmp_eq_u32 s33, 0
    s_cbranch_scc1 L_warm_2_0
    s_cmp_eq_u32 s33, 1
    s_cbranch_scc1 L_warm_2_1
    s_cmp_eq_u32 s33, 2
    s_cbranch_scc1 L_warm_2_2
    s_branch L_warm_2_3
L_wret_2:
    s_mov_b64 exec, -1
    ds_read2_b32 v[64:65], v244 offset0:176 offset1:177
    ds_read2_b32 v[66:67], v244 offset0:178 offset1:179
    ds_read2_b32 v[68:69], v244 offset0:48 offset1:49
    ds_read2_b32 v[70:71], v244 offset0:50 offset1:51
    ds_read2_b32 v[72:73], v245 offset0:176 offset1:177
    ds_read2_b32 v[74:75], v245 offset0:178 offset1:179
    ds_read2_b32 v[76:77], v245 offset0:48 offset1:49
    ds_read2_b32 v[78:79], v245 offset0:50 offset1:51
    ds_read2_b32 v[80:81], v244 offset0:160 offset1:161
    ds_read2_b32 v[82:83], v244 offset0:162 offset1:163
    ds_read2_b32 v[84:85], v244 offset0:32 offset1:33
    ds_read2_b32 v[86:87], v244 offset0:34 offset1:35
    ds_read2_b32 v[88:89], v245 offset0:160 offset1:161
    ds_read2_b32 v[90:91], v245 offset0:162 offset1:163
    ds_read2_b32 v[92:93], v245 offset0:32 offset1:33
    ds_read2_b32 v[94:95], v245 offset0:34 offset1:35
    ds_read2_b32 v[96:97], v244 offset0:144 offset1:145
    ds_read2_b32 v[98:99], v244 offset0:146 offset1:147
    ds_read2_b32 v[100:101], v244 offset0:16 offset1:17
    ds_read2_b32 v[102:103], v244 offset0:18 offset1:19
    ds_read2_b32 v[104:105], v245 offset0:144 offset1:145
    ds_read2_b32 v[106:107], v245 offset0:146 offset1:147
    ds_read2_b32 v[108:109], v245 offset0:16 offset1:17
    ds_read2_b32 v[110:111], v245 offset0:18 offset1:19
    ds_read2_b32 v[112:113], v244 offset0:128 offset1:129
    ds_read2_b32 v[114:115], v244 offset0:130 offset1:131
L_warm_1_2:
    s_cbranch_execz L_wret_1
    ds_read2_b32 v[116:117], v244 offset0:0 offset1:1
    ds_read2_b32 v[118:119], v244 offset0:2 offset1:3
    v_mov_b32 v219, 0
    s_mov_b64 exec, s[0:1]
    buffer_atomic_add v219, v253, s[8:11], s99 offen sc0 sc1
    s_mov_b64 exec, -1
    s_waitcnt vmcnt(1)
    s_barrier
    v_mov_b32 v16, 1
    s_mov_b64 exec, s[58:59]
    buffer_atomic_add v16, v252, s[8:11], s98 offen sc1
    s_mov_b64 exec, -1
    s_add_u32 s98, s98, 32768
    v_mov_b32 v16, 0x3727c5ac
    v_mov_b32 v17, 0x3727c5ac
    s_mov_b32 s72, 163840
    s_mov_b32 s73, 172032
    s_mov_b32 s74, 167936
    s_mov_b32 s75, 176128
    s_mov_b64 exec, s[0:1]
    s_waitcnt vmcnt(1)
    v_cmp_ne_u32 vcc, 16, v219
    s_nop 0
    s_and_b64 exec, exec, vcc
    s_cbranch_scc1 L_poll_25
L_pollx_26:
    s_mov_b64 exec, -1
    s_waitcnt lgkmcnt(0)
    s_barrier
    buffer_load_dwordx4 v[24:27], v241, s[8:11], s72 offen sc1
    buffer_load_dwordx4 v[28:31], v241, s[8:11], s73 offen sc1
    buffer_load_dwordx4 v[20:23], v240, s[8:11], s4 offen sc1
    ds_read2_b32 v[120:121], v245 offset0:128 offset1:129
    ds_read2_b32 v[122:123], v245 offset0:130 offset1:131
    ds_read2_b32 v[124:125], v245 offset0:0 offset1:1
    ds_read2_b32 v[126:127], v245 offset0:2 offset1:3
    ds_read2_b32 a[192:193], v246 offset0:176 offset1:177
    ds_read2_b32 a[194:195], v246 offset0:178 offset1:179
    ds_read2_b32 a[196:197], v247 offset0:0 offset1:1
    ds_read2_b32 a[198:199], v247 offset0:8 offset1:9
    ds_read2_b32 a[200:201], v247 offset0:16 offset1:17
    ds_read2_b32 a[202:203], v247 offset0:24 offset1:25
    ds_read2_b32 a[204:205], v247 offset0:32 offset1:33
    ds_read_b128 a[208:211], v249
    v_mov_b32 v219, 0
    s_mov_b64 exec, s[56:57]
    buffer_atomic_add v219, v253, s[8:11], s99 offen sc0 sc1
    s_mov_b64 exec, -1
    v_mov_b32 v56, -1
    v_mov_b32 v57, -1
    v_mov_b32 v58, -1
    v_mov_b32 v59, -1
    s_waitcnt vmcnt(3)
    v_pk_mul_f32 v[24:25], v[24:25], s[82:83]
    v_pk_mul_f32 v[26:27], v[26:27], s[82:83]
    s_waitcnt vmcnt(2)
    v_pk_fma_f32 v[28:29], v[28:29], s[82:83], v[16:17]
    v_pk_fma_f32 v[30:31], v[30:31], s[82:83], v[16:17]
    v_pk_fma_f32 v[28:29], v[24:25], v[24:25], v[28:29] neg_lo:[1,0,0] neg_hi:[1,0,0]
    v_pk_fma_f32 v[30:31], v[26:27], v[26:27], v[30:31] neg_lo:[1,0,0] neg_hi:[1,0,0]
    v_max_f32 v28, v16, v28
    v_max_f32 v29, v16, v29
    v_max_f32 v30, v16, v30
    v_max_f32 v31, v16, v31
    v_rsq_f32 v28, v28
    v_rsq_f32 v29, v29
    v_rsq_f32 v30, v30
    v_rsq_f32 v31, v31
    s_waitcnt vmcnt(1)
    v_lshlrev_b32 v48, 16, v20
    v_and_b32 v49, 0xffff0000, v20
    v_lshlrev_b32 v50, 16, v21
    v_and_b32 v51, 0xffff0000, v21
    v_lshlrev_b32 v52, 16, v22
    v_and_b32 v53, 0xffff0000, v22
    v_lshlrev_b32 v54, 16, v23
    v_and_b32 v55, 0xffff0000, v23
    v_pk_mul_f32 v[24:25], v[24:25], v[28:29]
    v_pk_mul_f32 v[26:27], v[26:27], v[30:31]
    v_pk_fma_f32 v[32:33], v[48:49], v[28:29], v[24:25] neg_lo:[0,0,1] neg_hi:[0,0,1]
    v_pk_fma_f32 v[34:35], v[50:51], v[30:31], v[26:27] neg_lo:[0,0,1] neg_hi:[0,0,1]
    v_pk_fma_f32 v[36:37], v[52:53], v[28:29], v[24:25] neg_lo:[0,0,1] neg_hi:[0,0,1]
    v_pk_fma_f32 v[38:39], v[54:55], v[30:31], v[26:27] neg_lo:[0,0,1] neg_hi:[0,0,1]
    v_cvt_pk_bf16_f32 v20, v32, v33
    v_cvt_pk_bf16_f32 v22, v36, v37
    v_cvt_pk_bf16_f32 v21, v34, v35
    v_cvt_pk_bf16_f32 v23, v38, v39
    v_permlane16_swap_b32 v20, v22
    s_nop 0
    v_permlane16_swap_b32 v21, v23
    ds_write_b128 v242, v[20:23] offset:0
    v_pk_fma_f32 v[48:49], v[32:33], s[30:31], v[48:49] op_sel:[0,0,0] op_sel_hi:[1,0,1]
    v_pk_fma_f32 v[50:51], v[34:35], s[30:31], v[50:51] op_sel:[0,0,0] op_sel_hi:[1,0,1]
    v_pk_fma_f32 v[52:53], v[36:37], s[30:31], v[52:53] op_sel:[0,1,0] op_sel_hi:[1,1,1]
    v_pk_fma_f32 v[54:55], v[38:39], s[30:31], v[54:55] op_sel:[0,1,0] op_sel_hi:[1,1,1]
    s_mov_b64 exec, s[56:57]
    s_waitcnt vmcnt(0)
    v_cmp_ne_u32 vcc, 16, v219
    s_nop 0
    s_and_b64 exec, exec, vcc
    s_cbranch_scc1 L_poll_27
L_pollx_28:
    s_mov_b64 exec, -1
    s_add_u32 s99, s99, 32768
    s_waitcnt lgkmcnt(0)
    s_barrier
    ds_read_b128 v[128:131], v243 offset:192
    ds_read_b128 v[132:135], v243 offset:704
    ds_read_b128 v[136:139], v243 offset:1216
    buffer_load_dwordx4 v[184:187], v241, s[8:11], s74 offen sc1
    s_mul_i32 s76, s69, 240
    v_add_u32 v200, s76, v243
    s_waitcnt lgkmcnt(2)
    v_mfma_f32_16x16x32_bf16 v[16:19], v[64:67], v[128:131], 0
    ds_read_b128 v[140:143], v243 offset:1728
    v_mov_b32 v192, 0x3727c5ac
    v_mfma_f32_16x16x32_bf16 v[20:23], v[68:71], v[128:131], 0
    buffer_load_dwordx4 v[188:191], v241, s[8:11], s75 offen sc1
    v_mfma_f32_16x16x32_bf16 v[24:27], v[72:75], v[128:131], 0
    ds_read_b128 v[144:147], v200 offset:192
    v_mfma_f32_16x16x32_bf16 v[28:31], v[76:79], v[128:131], 0
    buffer_load_dwordx4 v[180:183], v240, s[8:11], s5 offen sc1
    s_waitcnt lgkmcnt(2)
    v_mfma_f32_16x16x32_bf16 v[20:23], v[64:67], v[132:135], v[20:23]
    ds_read_b128 v[148:151], v200 offset:704
    v_mfma_f32_16x16x32_bf16 v[24:27], v[68:71], v[132:135], v[24:27]
    ds_read_b128 v[152:155], v200 offset:1216
    v_mfma_f32_16x16x32_bf16 v[28:31], v[72:75], v[132:135], v[28:31]
    buffer_store_dwordx4 v[56:59], v248, s[8:11], s78 offen sc1
    v_mfma_f32_16x16x32_bf16 v[24:27], v[64:67], v[136:139], v[24:27]
    ds_read_b128 v[156:159], v200 offset:1728
    v_mfma_f32_16x16x32_bf16 v[28:31], v[68:71], v[136:139], v[28:31]
    ds_read_b128 v[160:163], v243 offset:128
    s_waitcnt lgkmcnt(3)
    v_mfma_f32_16x16x32_bf16 v[28:31], v[64:67], v[140:143], v[28:31]
    ds_read_b128 v[164:167], v243 offset:640
    v_mfma_f32_16x16x32_bf16 v[32:35], v[144:147], a[208:211], 0
    ds_read_b128 v[168:171], v243 offset:1152
    v_mfma_f32_16x16x32_bf16 v[36:39], v[148:151], a[208:211], 0
    buffer_store_dwordx4 v[56:59], v248, s[8:11], s79 offen sc1
    s_waitcnt lgkmcnt(3)
    v_mfma_f32_16x16x32_bf16 v[40:43], v[152:155], a[208:211], 0
    ds_read_b128 v[128:131], v243 offset:1664
    v_mfma_f32_16x16x32_bf16 v[44:47], v[156:159], a[208:211], 0
    ds_read_b128 v[132:135], v243 offset:64
    s_waitcnt lgkmcnt(3)
    v_mfma_f32_16x16x32_bf16 v[16:19], v[80:83], v[160:163], v[16:19]
    ds_read_b128 v[136:139], v243 offset:576
    v_cvt_pk_bf16_f32 v172, v32, v33
    v_mfma_f32_16x16x32_bf16 v[20:23], v[84:87], v[160:163], v[20:23]
    v_cvt_pk_bf16_f32 v173, v34, v35
    v_cvt_pk_bf16_f32 v174, v36, v37
    v_mfma_f32_16x16x32_bf16 v[24:27], v[88:91], v[160:163], v[24:27]
    buffer_store_dwordx4 v[56:59], v211, s[8:11], s71 offen sc1
    v_mfma_f32_16x16x32_bf16 v[28:31], v[92:95], v[160:163], v[28:31]
    ds_read_b128 v[140:143], v243 offset:1088
    v_cvt_pk_bf16_f32 v175, v38, v39
    v_mfma_f32_16x16x32_bf16 v[20:23], v[80:83], v[164:167], v[20:23]
    v_cvt_pk_bf16_f32 v176, v40, v41
    v_cvt_pk_bf16_f32 v177, v42, v43
    v_mfma_f32_16x16x32_bf16 v[24:27], v[84:87], v[164:167], v[24:27]
    ds_read_b128 v[144:147], v243 offset:1600
    v_cvt_pk_bf16_f32 v178, v44, v45
    v_mfma_f32_16x16x32_bf16 v[28:31], v[88:91], v[164:167], v[28:31]
    ds_read_b128 v[148:151], v243 offset:0
    s_waitcnt lgkmcnt(3)
    v_mfma_f32_16x16x32_bf16 v[24:27], v[80:83], v[168:171], v[24:27]
    ds_read_b128 v[152:155], v243 offset:512
    v_cvt_pk_bf16_f32 v179, v46, v47
    v_mfma_f32_16x16x32_bf16 v[28:31], v[84:87], v[168:171], v[28:31]
    v_mfma_f32_16x16x32_bf16 v[28:31], v[80:83], v[128:131], v[28:31]
    ds_read_b128 v[156:159], v243 offset:1024
    v_mfma_f32_16x16x32_bf16 v[16:19], v[96:99], v[132:135], v[16:19]
    v_mfma_f32_16x16x32_bf16 v[20:23], v[100:103], v[132:135], v[20:23]
    v_mfma_f32_16x16x32_bf16 v[24:27], v[104:107], v[132:135], v[24:27]
    ds_read_b128 v[160:163], v243 offset:1536
    v_mfma_f32_16x16x32_bf16 v[28:31], v[108:111], v[132:135], v[28:31]
    v_mfma_f32_16x16x32_bf16 v[20:23], v[96:99], v[136:139], v[20:23]
    v_mfma_f32_16x16x32_bf16 v[24:27], v[100:103], v[136:139], v[24:27]
    v_mfma_f32_16x16x32_bf16 v[28:31], v[104:107], v[136:139], v[28:31]
    s_waitcnt lgkmcnt(1)
    v_mfma_f32_16x16x32_bf16 v[24:27], v[96:99], v[140:143], v[24:27]
    v_mfma_f32_16x16x32_bf16 v[28:31], v[100:103], v[140:143], v[28:31]
    s_waitcnt vmcnt(5)
    v_mul_f32 v184, s82, v184
    v_mfma_f32_16x16x32_bf16 v[28:31], v[96:99], v[144:147], v[28:31]
    v_mul_f32 v185, s82, v185
    v_mul_f32 v186, s82, v186
    v_mfma_f32_16x16x32_bf16 v[16:19], v[112:115], v[148:151], v[16:19]
    v_mul_f32 v187, s82, v187
    v_mfma_f32_16x16x32_bf16 v[20:23], v[112:115], v[152:155], v[20:23]
    s_waitcnt vmcnt(4)
    v_fma_f32 v188, v188, s82, v192
    v_mfma_f32_16x16x32_bf16 v[20:23], v[116:119], v[148:151], v[20:23]
    v_fma_f32 v189, v189, s82, v192
    v_fma_f32 v190, v190, s82, v192
    v_mfma_f32_16x16x32_bf16 v[24:27], v[112:115], v[156:159], v[24:27]
    v_fma_f32 v191, v191, s82, v192
    v_fma_f32 v188, -v184, v184, v188
    v_mfma_f32_16x16x32_bf16 v[24:27], v[116:119], v[152:155], v[24:27]
    v_max_f32 v188, 0x3727c5ac, v188
    v_rsq_f32 v188, v188
    v_mfma_f32_16x16x32_bf16 v[24:27], v[120:123], v[148:151], v[24:27]
    v_fma_f32 v189, -v185, v185, v189
    s_waitcnt lgkmcnt(0)
    v_mfma_f32_16x16x32_bf16 v[28:31], v[112:115], v[160:163], v[28:31]
    v_max_f32 v189, 0x3727c5ac, v189
    v_rsq_f32 v189, v189
    v_mfma_f32_16x16x32_bf16 v[28:31], v[116:119], v[156:159], v[28:31]
    ds_write_b128 v250, v[16:19] offset:0
    v_mfma_f32_16x16x32_bf16 v[28:31], v[120:123], v[152:155], v[28:31]
    ds_read_b128 v[164:167], v243 offset:640
    v_fma_f32 v190, -v186, v186, v190
    v_mfma_f32_16x16x32_bf16 v[28:31], v[124:127], v[148:151], v[28:31]
    ds_read_b128 v[168:171], v243 offset:1152
    v_max_f32 v190, 0x3727c5ac, v190
    v_mfma_f32_16x16x32_bf16 v[32:35], v[124:127], v[152:155], 0
    ds_write_b128 v250, v[20:23] offset:1024
    v_mfma_f32_16x16x32_bf16 v[32:35], v[120:123], v[156:159], v[32:35]
    ds_read_b128 v[128:131], v243 offset:1664
    v_rsq_f32 v190, v190
    v_mfma_f32_16x16x32_bf16 v[36:39], v[124:127], v[156:159], 0
    v_fma_f32 v191, -v187, v187, v191
    v_max_f32 v191, 0x3727c5ac, v191
    v_mfma_f32_16x16x32_bf16 v[32:35], v[116:119], v[160:163], v[32:35]
    ds_write_b128 v250, v[24:27] offset:2048
    v_mfma_f32_16x16x32_bf16 v[36:39], v[120:123], v[160:163], v[36:39]
    ds_read_b128 v[132:135], v243 offset:192
    v_rsq_f32 v191, v191
    v_mfma_f32_16x16x32_bf16 v[40:43], v[124:127], v[160:163], 0
    s_waitcnt vmcnt(3)
    v_lshlrev_b32 v56, 16, v180
    v_mfma_f32_16x16x32_bf16 v[32:35], v[108:111], v[136:139], v[32:35]
    ds_write_b128 v250, v[28:31] offset:3072
    v_mfma_f32_16x16x32_bf16 v[32:35], v[104:107], v[140:143], v[32:35]
    ds_read_b128 v[136:139], v243 offset:704
    v_and_b32 v57, 0xffff0000, v180
    v_mfma_f32_16x16x32_bf16 v[36:39], v[108:111], v[140:143], v[36:39]
    ds_read_b128 v[140:143], v243 offset:1216
    v_lshlrev_b32 v58, 16, v181
    v_mfma_f32_16x16x32_bf16 v[32:35], v[100:103], v[144:147], v[32:35]
    v_and_b32 v59, 0xffff0000, v181
    v_lshlrev_b32 v60, 16, v182
    v_mfma_f32_16x16x32_bf16 v[36:39], v[104:107], v[144:147], v[36:39]
    v_and_b32 v61, 0xffff0000, v182
    v_lshlrev_b32 v62, 16, v183
    v_mfma_f32_16x16x32_bf16 v[40:43], v[108:111], v[144:147], v[40:43]
    ds_read_b128 v[144:147], v243 offset:1728
    s_waitcnt lgkmcnt(4)
    v_mfma_f32_16x16x32_bf16 v[32:35], v[92:95], v[164:167], v[32:35]
    v_and_b32 v63, 0xffff0000, v183
    v_mul_f32 v184, v184, v188
    v_mfma_f32_16x16x32_bf16 v[32:35], v[88:91], v[168:171], v[32:35]
    v_mul_f32 v185, v185, v189
    v_mul_f32 v186, v186, v190
    v_mfma_f32_16x16x32_bf16 v[36:39], v[92:95], v[168:171], v[36:39]
    v_mul_f32 v187, v187, v191
    v_fma_f32 v192, v56, v188, -v184
    v_mfma_f32_16x16x32_bf16 v[32:35], v[84:87], v[128:131], v[32:35]
    v_fma_f32 v193, v57, v189, -v185
    v_fma_f32 v194, v58, v190, -v186
    v_mfma_f32_16x16x32_bf16 v[36:39], v[88:91], v[128:131], v[36:39]
    v_fma_f32 v195, v59, v191, -v187
    v_fma_f32 v196, v60, v188, -v184
    v_mfma_f32_16x16x32_bf16 v[40:43], v[92:95], v[128:131], v[40:43]
    v_fma_f32 v197, v61, v189, -v185
    v_fma_f32 v198, v62, v190, -v186
    v_mfma_f32_16x16x32_bf16 v[32:35], a[192:195], v[132:135], v[32:35]
    v_fma_f32 v199, v63, v191, -v187
    s_waitcnt lgkmcnt(0)
    v_mfma_f32_16x16x32_bf16 v[32:35], v[76:79], v[136:139], v[32:35]
    v_cvt_pk_bf16_f32 v180, v192, v193
    v_cvt_pk_bf16_f32 v182, v196, v197
    v_mfma_f32_16x16x32_bf16 v[36:39], a[192:195], v[136:139], v[36:39]
    v_cvt_pk_bf16_f32 v181, v194, v195
    v_cvt_pk_bf16_f32 v183, v198, v199
    v_mfma_f32_16x16x32_bf16 v[32:35], v[72:75], v[140:143], v[32:35]
    v_permlane16_swap_b32 v180, v182
    v_mfma_f32_16x16x32_bf16 v[36:39], v[76:79], v[140:143], v[36:39]
    v_permlane16_swap_b32 v181, v183
    v_mfma_f32_16x16x32_bf16 v[40:43], a[192:195], v[140:143], v[40:43]
    ds_write_b128 v242, v[180:183] offset:2048
    v_mfma_f32_16x16x32_bf16 v[32:35], v[68:71], v[144:147], v[32:35]
    v_fmac_f32 v56, s30, v192
    v_fmac_f32 v57, s30, v193
    v_mfma_f32_16x16x32_bf16 v[36:39], v[72:75], v[144:147], v[36:39]
    v_fmac_f32 v58, s30, v194
    v_fmac_f32 v59, s30, v195
    v_mfma_f32_16x16x32_bf16 v[40:43], v[76:79], v[144:147], v[40:43]
    v_fmac_f32 v60, s31, v196
    v_fmac_f32 v61, s31, v197
    v_mfma_f32_16x16x32_bf16 v[44:47], a[192:195], v[144:147], 0
    v_fmac_f32 v62, s31, v198
    v_fmac_f32 v63, s31, v199
    v_mfma_f32_16x16x32_bf16 v[32:35], v[172:175], a[202:205], v[32:35]
    v_mfma_f32_16x16x32_bf16 v[36:39], v[172:175], a[200:203], v[36:39]
    s_waitcnt lgkmcnt(0)
    s_barrier
    ds_read_b128 v[148:151], v243 offset:2240
    v_mfma_f32_16x16x32_bf16 v[40:43], v[172:175], a[198:201], v[40:43]
    ds_read_b128 v[152:155], v243 offset:2752
    ds_read_b128 v[16:19], v251 offset:0
    v_mfma_f32_16x16x32_bf16 v[44:47], v[172:175], a[196:199], v[44:47]
    ds_read_b128 v[156:159], v243 offset:3264
    ds_read_b128 v[20:23], v251 offset:4096
    v_mfma_f32_16x16x32_bf16 v[40:43], v[176:179], a[202:205], v[40:43]
    ds_read_b128 v[160:163], v243 offset:3776
    ds_read_b128 v[24:27], v251 offset:8192
    v_mfma_f32_16x16x32_bf16 v[44:47], v[176:179], a[200:203], v[44:47]
    ds_read_b128 v[164:167], v243 offset:2176
    s_waitcnt lgkmcnt(7)
    v_mfma_f32_16x16x32_bf16 v[32:35], v[64:67], v[148:151], v[32:35]
    ds_read_b128 v[168:171], v243 offset:2688
    ds_read_b128 v[28:31], v251 offset:12288
    v_mfma_f32_16x16x32_bf16 v[36:39], v[68:71], v[148:151], v[36:39]
    v_mfma_f32_16x16x32_bf16 v[40:43], v[72:75], v[148:151], v[40:43]
    s_waitcnt lgkmcnt(6)
    v_add_f32 v48, v48, v16
    v_mfma_f32_16x16x32_bf16 v[44:47], v[76:79], v[148:151], v[44:47]
    ds_read_b128 v[128:131], v243 offset:3200
    v_add_f32 v49, v49, v17
    v_mfma_f32_16x16x32_bf16 v[36:39], v[64:67], v[152:155], v[36:39]
    v_add_f32 v50, v50, v18
    v_add_f32 v51, v51, v19
    v_mfma_f32_16x16x32_bf16 v[40:43], v[68:71], v[152:155], v[40:43]
    ds_read_b128 v[132:135], v243 offset:3712
    s_waitcnt lgkmcnt(3)
    v_add_f32 v48, v48, v20
    v_mfma_f32_16x16x32_bf16 v[44:47], v[72:75], v[152:155], v[44:47]
    ds_read_b128 v[136:139], v243 offset:2112
    v_add_f32 v49, v49, v21
    v_mfma_f32_16x16x32_bf16 v[40:43], v[64:67], v[156:159], v[40:43]
    ds_read_b128 v[140:143], v243 offset:2048
    v_add_f32 v50, v50, v22
    v_mfma_f32_16x16x32_bf16 v[44:47], v[68:71], v[156:159], v[44:47]
    v_add_f32 v51, v51, v23
    v_add_f32 v52, v52, v24
    v_mfma_f32_16x16x32_bf16 v[44:47], v[64:67], v[160:163], v[44:47]
    v_add_f32 v53, v53, v25
    v_add_f32 v54, v54, v26
    v_mfma_f32_16x16x32_bf16 v[32:35], v[80:83], v[164:167], v[32:35]
    ds_read_b128 v[144:147], v243 offset:2624
    v_add_f32 v55, v55, v27
    v_mfma_f32_16x16x32_bf16 v[36:39], v[84:87], v[164:167], v[36:39]
    ds_read_b128 v[148:151], v243 offset:2560
    s_waitcnt lgkmcnt(3)
    v_add_f32 v52, v52, v28
    v_mfma_f32_16x16x32_bf16 v[40:43], v[88:91], v[164:167], v[40:43]
    v_add_f32 v53, v53, v29
    v_add_f32 v54, v54, v30
    v_mfma_f32_16x16x32_bf16 v[44:47], v[92:95], v[164:167], v[44:47]
    v_add_f32 v55, v55, v31
    v_cvt_pk_bf16_f32 v200, v48, v49
    v_mfma_f32_16x16x32_bf16 v[36:39], v[80:83], v[168:171], v[36:39]
    v_cvt_pk_bf16_f32 v202, v52, v53
    v_cvt_pk_bf16_f32 v201, v50, v51
    v_mfma_f32_16x16x32_bf16 v[40:43], v[84:87], v[168:171], v[40:43]
    v_cvt_pk_bf16_f32 v203, v54, v55
    v_permlane16_swap_b32 v200, v202
    v_mfma_f32_16x16x32_bf16 v[44:47], v[88:91], v[168:171], v[44:47]
    ds_read_b128 v[152:155], v243 offset:3136
    v_permlane16_swap_b32 v201, v203
    v_mfma_f32_16x16x32_bf16 v[40:43], v[80:83], v[128:131], v[40:43]
    ds_read_b128 v[156:159], v243 offset:3072
    s_waitcnt vmcnt(0)
    v_mfma_f32_16x16x32_bf16 v[44:47], v[84:87], v[128:131], v[44:47]
    buffer_store_dwordx4 v[200:203], v248, s[8:11], s78 offen sc1
    v_mfma_f32_16x16x32_bf16 v[44:47], v[80:83], v[132:135], v[44:47]
    v_mfma_f32_16x16x32_bf16 v[32:35], v[96:99], v[136:139], v[32:35]
    s_waitcnt lgkmcnt(1)
    v_mfma_f32_16x16x32_bf16 v[32:35], v[112:115], v[140:143], v[32:35]
    v_mfma_f32_16x16x32_bf16 v[36:39], v[100:103], v[136:139], v[36:39]
    v_mfma_f32_16x16x32_bf16 v[36:39], v[116:119], v[140:143], v[36:39]
    v_mfma_f32_16x16x32_bf16 v[36:39], v[96:99], v[144:147], v[36:39]
    ds_read_b128 v[160:163], v243 offset:3648
    v_mfma_f32_16x16x32_bf16 v[36:39], v[112:115], v[148:151], v[36:39]
    ds_read_b128 v[164:167], v243 offset:3584
    v_mfma_f32_16x16x32_bf16 v[40:43], v[104:107], v[136:139], v[40:43]
    v_mfma_f32_16x16x32_bf16 v[40:43], v[120:123], v[140:143], v[40:43]
    ds_write_b128 v250, v[32:35] offset:16384
    v_mfma_f32_16x16x32_bf16 v[40:43], v[100:103], v[144:147], v[40:43]
    v_mfma_f32_16x16x32_bf16 v[40:43], v[116:119], v[148:151], v[40:43]
    v_mfma_f32_16x16x32_bf16 v[40:43], v[96:99], v[152:155], v[40:43]
    s_waitcnt lgkmcnt(1)
    v_mfma_f32_16x16x32_bf16 v[40:43], v[112:115], v[156:159], v[40:43]
    ds_write_b128 v250, v[36:39] offset:17408
    v_mfma_f32_16x16x32_bf16 v[44:47], v[108:111], v[136:139], v[44:47]
    v_mfma_f32_16x16x32_bf16 v[44:47], v[124:127], v[140:143], v[44:47]
    v_mfma_f32_16x16x32_bf16 v[44:47], v[104:107], v[144:147], v[44:47]
    v_mfma_f32_16x16x32_bf16 v[44:47], v[120:123], v[148:151], v[44:47]
    v_mfma_f32_16x16x32_bf16 v[44:47], v[100:103], v[152:155], v[44:47]
    v_mfma_f32_16x16x32_bf16 v[44:47], v[116:119], v[156:159], v[44:47]
    v_mfma_f32_16x16x32_bf16 v[44:47], v[96:99], v[160:163], v[44:47]
    ds_write_b128 v250, v[40:43] offset:18432
    v_mfma_f32_16x16x32_bf16 v[44:47], v[112:115], v[164:167], v[44:47]
    s_nop 7
    ds_write_b128 v250, v[44:47] offset:19456
    s_waitcnt lgkmcnt(0)
    s_barrier
    v_mov_b32 v16, 1
    s_mov_b64 exec, s[0:1]
    buffer_atomic_add v16, v252, s[8:11], s98 offen sc1
    s_mov_b64 exec, -1
    ds_read_b128 v[64:67], v251 offset:16384
    ds_read_b128 v[68:71], v251 offset:20480
    ds_read_b128 v[72:75], v251 offset:24576
    ds_read_b128 v[76:79], v251 offset:28672
    s_waitcnt lgkmcnt(3)
    v_pk_add_f32 v[56:57], v[56:57], v[64:65]
    v_pk_add_f32 v[58:59], v[58:59], v[66:67]
    s_waitcnt lgkmcnt(2)
    v_pk_add_f32 v[56:57], v[56:57], v[68:69]
    v_pk_add_f32 v[58:59], v[58:59], v[70:71]
    s_waitcnt lgkmcnt(1)
    v_pk_add_f32 v[60:61], v[60:61], v[72:73]
    v_pk_add_f32 v[62:63], v[62:63], v[74:75]
    s_waitcnt lgkmcnt(0)
    v_pk_add_f32 v[60:61], v[60:61], v[76:77]
    v_pk_add_f32 v[62:63], v[62:63], v[78:79]
    v_cvt_pk_bf16_f32 v200, v56, v57
    v_cvt_pk_bf16_f32 v202, v60, v61
    v_cvt_pk_bf16_f32 v201, v58, v59
    v_cvt_pk_bf16_f32 v203, v62, v63
    v_permlane16_swap_b32 v200, v202
    s_nop 0
    v_permlane16_swap_b32 v201, v203
    buffer_store_dwordx4 v[200:203], v248, s[8:11], s79 offen sc1
    s_barrier
    v_mov_b32 v16, 1
    s_mov_b64 exec, s[56:57]
    buffer_atomic_add v16, v252, s[8:11], s98 offen sc1
    s_mov_b64 exec, -1
    s_add_u32 s98, s98, 32768
    s_lshl2_add_u32 s72, s32, 98304
    v_add_u32 v16, s72, v204
    v_add_u32 v17, s72, v205
    v_add_u32 v18, s72, v206
    v_add_u32 v19, s72, v207
    v_add_u32 v20, s72, v211
    ds_read_b64_tr_b16 v[64:65], v16 offset:0
    ds_read_b64_tr_b16 v[66:67], v16 offset:2048
    ds_read_b64_tr_b16 v[68:69], v17 offset:0
    ds_read_b64_tr_b16 v[70:71], v17 offset:2048
    ds_read_b64_tr_b16 v[72:73], v18 offset:0
    ds_read_b64_tr_b16 v[74:75], v18 offset:2048
    ds_read_b64_tr_b16 v[76:77], v19 offset:0
    ds_read_b64_tr_b16 v[78:79], v19 offset:2048
    ds_read_b64_tr_b16 v[80:81], v16 offset:4096
    ds_read_b64_tr_b16 v[82:83], v16 offset:6144
    ds_read_b64_tr_b16 v[84:85], v17 offset:4096
    ds_read_b64_tr_b16 v[86:87], v17 offset:6144
    ds_read_b64_tr_b16 v[88:89], v18 offset:4096
    ds_read_b64_tr_b16 v[90:91], v18 offset:6144
    ds_read_b64_tr_b16 v[92:93], v19 offset:4096
    ds_read_b64_tr_b16 v[94:95], v19 offset:6144
    ds_read_b64_tr_b16 v[96:97], v16 offset:8192
    ds_read_b64_tr_b16 v[98:99], v16 offset:10240
    ds_read_b64_tr_b16 v[100:101], v17 offset:8192
    ds_read_b64_tr_b16 v[102:103], v17 offset:10240
    ds_read_b64_tr_b16 v[104:105], v18 offset:8192
    ds_read_b64_tr_b16 v[106:107], v18 offset:10240
    ds_read_b64_tr_b16 v[108:109], v19 offset:8192
    ds_read_b64_tr_b16 v[110:111], v19 offset:10240
    ds_read_b64_tr_b16 v[112:113], v16 offset:12288
    ds_read_b64_tr_b16 v[114:115], v16 offset:14336
    ds_read_b64_tr_b16 v[116:117], v17 offset:12288
    ds_read_b64_tr_b16 v[118:119], v17 offset:14336
    ds_read_b64_tr_b16 v[120:121], v18 offset:12288
    ds_read_b64_tr_b16 v[122:123], v18 offset:14336
    ds_read_b64_tr_b16 v[124:125], v19 offset:12288
    ds_read_b64_tr_b16 v[126:127], v19 offset:14336
    s_waitcnt lgkmcnt(0)
    ds_write_b128 v20, v[64:67] offset:0
    ds_write_b128 v20, v[68:71] offset:1024
    ds_write_b128 v20, v[72:75] offset:2048
    ds_write_b128 v20, v[76:79] offset:3072
    ds_write_b128 v20, v[80:83] offset:4096
    ds_write_b128 v20, v[84:87] offset:5120
    ds_write_b128 v20, v[88:91] offset:6144
    ds_write_b128 v20, v[92:95] offset:7168
    ds_write_b128 v20, v[96:99] offset:8192
    ds_write_b128 v20, v[100:103] offset:9216
    v_mov_b32 v219, 0
    s_mov_b64 exec, s[58:59]
    buffer_atomic_add v219, v253, s[8:11], s99 offen sc0 sc1
    s_mov_b64 exec, -1
    ds_write_b128 v20, v[104:107] offset:10240
    ds_write_b128 v20, v[108:111] offset:11264
    ds_write_b128 v20, v[112:115] offset:12288
    ds_write_b128 v20, v[116:119] offset:13312
    ds_write_b128 v20, v[120:123] offset:14336
    ds_write_b128 v20, v[124:127] offset:15360
    s_waitcnt vmcnt(0)
    s_mov_b64 s[52:53], -1
    s_mov_b32 s54, s33
    s_sub_u32 s55, s98, 32768
    s_mov_b64 exec, s[58:59]
    s_waitcnt vmcnt(0)
    v_cmp_ne_u32 vcc, 16, v219
    s_nop 0
    s_and_b64 exec, exec, vcc
    s_cbranch_scc1 L_poll_29
L_pollx_30:
    s_mov_b64 exec, -1
    s_add_u32 s99, s99, 32768
    s_waitcnt lgkmcnt(0)
    s_barrier
L_qkv_again_1:
    s_add_u32 m0, s40, 0
    s_add_u32 s94, s39, 0
    buffer_load_dwordx4 v209, s[8:11], s94 offen sc1 lds
    s_add_u32 m0, s40, 4096
    s_add_u32 s94, s39, 4096
    buffer_load_dwordx4 v209, s[8:11], s94 offen sc1 lds
    s_add_u32 m0, s40, 8192
    s_add_u32 s94, s39, 8192
    buffer_load_dwordx4 v209, s[8:11], s94 offen sc1 lds
    s_add_u32 m0, s40, 12288
    s_add_u32 s94, s39, 12288
    buffer_load_dwordx4 v209, s[8:11], s94 offen sc1 lds
    s_add_u32 m0, s32, 16384
    s_add_u32 s89, s37, 16384
    buffer_load_dwordx4 v209, s[8:11], s89 offen offset:0 sc1 lds
    buffer_load_dwordx4 v209, s[8:11], s89 offen offset:1024 sc1 lds
    buffer_load_dwordx4 v209, s[8:11], s89 offen offset:2048 sc1 lds
    buffer_load_dwordx4 v209, s[8:11], s89 offen offset:3072 sc1 lds
    s_add_u32 m0, s32, 32768
    s_add_u32 s89, s37, 32768
    buffer_load_dwordx4 v209, s[8:11], s89 offen offset:0 sc1 lds
    s_waitcnt vmcnt(7)
    s_barrier
    ds_read_b64_tr_b16 a[192:193], v207 offset:0
    ds_read_b64_tr_b16 a[194:195], v207 offset:2048
    ds_read_b64_tr_b16 v[146:147], v204 offset:0
    ds_read_b64_tr_b16 v[148:149], v204 offset:2048
    ds_read_b64_tr_b16 v[80:81], v205 offset:0
    ds_read_b64_tr_b16 v[82:83], v205 offset:2048
    ds_read_b64_tr_b16 v[150:151], v208 offset:0
    ds_read_b64_tr_b16 v[152:153], v208 offset:2048
    ds_read_b64_tr_b16 a[196:197], v207 offset:4096
    ds_read_b64_tr_b16 a[198:199], v207 offset:6144
    ds_read_b64_tr_b16 v[154:155], v204 offset:4096
    ds_read_b64_tr_b16 v[156:157], v204 offset:6144
    v_mov_b32 v186, 0x3727c5ac
    s_waitcnt lgkmcnt(10)
    v_mfma_f32_16x16x32_bf16 v[44:47], a[64:67], a[192:195], 0
    buffer_load_dwordx4 v209, s[8:11], s89 offen offset:1024 sc1 lds
    v_mfma_f32_16x16x32_bf16 v[60:63], a[192:195], a[128:131], 0
    ds_read_b64_tr_b16 v[84:85], v205 offset:4096
    s_waitcnt lgkmcnt(9)
    v_mfma_f32_16x16x32_bf16 v[32:35], a[64:67], v[146:149], 0
    ds_read_b64_tr_b16 v[86:87], v205 offset:6144
    v_mfma_f32_16x16x32_bf16 v[16:19], a[0:3], v[146:149], 0
    ds_read_b64_tr_b16 v[158:159], v208 offset:4096
    v_mfma_f32_16x16x32_bf16 v[48:51], v[146:149], a[128:131], 0
    buffer_load_dwordx4 v209, s[8:11], s89 offen offset:2048 sc1 lds
    s_waitcnt lgkmcnt(3)
    v_mfma_f32_16x16x32_bf16 v[36:39], a[64:67], v[80:83], 0
    ds_read_b64_tr_b16 v[160:161], v208 offset:6144
    v_mfma_f32_16x16x32_bf16 v[20:23], a[0:3], v[80:83], 0
    s_waitcnt vmcnt(7)
    s_barrier
    ds_read_b64_tr_b16 a[200:201], v207 offset:8192
    v_mfma_f32_16x16x32_bf16 v[52:55], v[80:83], a[128:131], 0
    ds_read_b64_tr_b16 a[202:203], v207 offset:10240
    v_mfma_f32_16x16x32_bf16 v[64:67], v[150:153], v[150:153], 0
    buffer_load_dwordx4 v209, s[8:11], s89 offen offset:3072 sc1 lds
    v_mfma_f32_16x16x32_bf16 v[68:71], v[236:239], v[150:153], 0
    ds_read_b64_tr_b16 v[162:163], v204 offset:8192
    s_add_u32 m0, s32, 49152
    v_mfma_f32_16x16x32_bf16 v[44:47], a[68:71], a[196:199], v[44:47]
    ds_read_b64_tr_b16 v[164:165], v204 offset:10240
    s_add_u32 s89, s37, 49152
    v_mfma_f32_16x16x32_bf16 v[60:63], a[196:199], a[132:135], v[60:63]
    ds_read_b64_tr_b16 v[166:167], v208 offset:8192
    v_mfma_f32_16x16x32_bf16 v[32:35], a[68:71], v[154:157], v[32:35]
    buffer_load_dwordx4 v209, s[8:11], s89 offen offset:0 sc1 lds
    v_mfma_f32_16x16x32_bf16 v[16:19], a[4:7], v[154:157], v[16:19]
    ds_read_b64_tr_b16 v[168:169], v208 offset:10240
    v_mfma_f32_16x16x32_bf16 v[48:51], v[154:157], a[132:135], v[48:51]
    ds_read_b64_tr_b16 a[204:205], v207 offset:12288
    s_waitcnt lgkmcnt(4)
    v_mfma_f32_16x16x32_bf16 v[36:39], a[68:71], v[84:87], v[36:39]
    ds_read_b64_tr_b16 a[206:207], v207 offset:14336
    v_mfma_f32_16x16x32_bf16 v[20:23], a[4:7], v[84:87], v[20:23]
    buffer_load_dwordx4 v209, s[8:11], s89 offen offset:1024 sc1 lds
    v_mfma_f32_16x16x32_bf16 v[52:55], v[84:87], a[132:135], v[52:55]
    ds_read_b64_tr_b16 v[170:171], v204 offset:12288
    v_mfma_f32_16x16x32_bf16 v[64:67], v[158:161], v[158:161], v[64:67]
    ds_read_b64_tr_b16 v[172:173], v204 offset:14336
    v_mfma_f32_16x16x32_bf16 v[68:71], v[236:239], v[158:161], v[68:71]
    ds_read_b64_tr_b16 v[174:175], v208 offset:12288
    v_mfma_f32_16x16x32_bf16 v[44:47], a[72:75], a[200:203], v[44:47]
    buffer_load_dwordx4 v209, s[8:11], s89 offen offset:2048 sc1 lds
    v_mfma_f32_16x16x32_bf16 v[60:63], a[200:203], a[136:139], v[60:63]
    ds_read_b64_tr_b16 v[176:177], v208 offset:14336
    s_waitcnt lgkmcnt(4)
    v_mfma_f32_16x16x32_bf16 v[32:35], a[72:75], v[162:165], v[32:35]
    s_waitcnt vmcnt(7)
L_warm_1_3:
    s_cbranch_execz L_wret_1
    s_barrier
    ds_read_b64_tr_b16 a[208:209], v207 offset:16384
    v_mfma_f32_16x16x32_bf16 v[16:19], a[8:11], v[162:165], v[16:19]
    ds_read_b64_tr_b16 a[210:211], v207 offset:18432
    v_mfma_f32_16x16x32_bf16 v[48:51], v[162:165], a[136:139], v[48:51]
    buffer_load_dwordx4 v209, s[8:11], s89 offen offset:3072 sc1 lds
    v_mfma_f32_16x16x32_bf16 v[64:67], v[166:169], v[166:169], v[64:67]
    ds_read_b64_tr_b16 v[146:147], v204 offset:16384
    v_mfma_f32_16x16x32_bf16 v[68:71], v[236:239], v[166:169], v[68:71]
    ds_read_b64_tr_b16 v[148:149], v204 offset:18432
    v_mfma_f32_16x16x32_bf16 v[44:47], a[76:79], a[204:207], v[44:47]
    v_mfma_f32_16x16x32_bf16 v[60:63], a[204:207], a[140:143], v[60:63]
    ds_read_b64_tr_b16 v[150:151], v208 offset:16384
    s_waitcnt lgkmcnt(3)
    v_mfma_f32_16x16x32_bf16 v[32:35], a[76:79], v[170:173], v[32:35]
    ds_read_b64_tr_b16 v[152:153], v208 offset:18432
    v_mfma_f32_16x16x32_bf16 v[16:19], a[12:15], v[170:173], v[16:19]
    ds_read_b64_tr_b16 a[212:213], v207 offset:20480
    v_mfma_f32_16x16x32_bf16 v[48:51], v[170:173], a[140:143], v[48:51]
    ds_read_b64_tr_b16 a[214:215], v207 offset:22528
    v_mfma_f32_16x16x32_bf16 v[64:67], v[174:177], v[174:177], v[64:67]
    ds_read_b64_tr_b16 v[154:155], v204 offset:20480
    v_mfma_f32_16x16x32_bf16 v[68:71], v[236:239], v[174:177], v[68:71]
    ds_read_b64_tr_b16 v[156:157], v204 offset:22528
    v_mfma_f32_16x16x32_bf16 v[44:47], a[80:83], a[208:211], v[44:47]
    v_mfma_f32_16x16x32_bf16 v[60:63], a[208:211], a[144:147], v[60:63]
    ds_read_b64_tr_b16 v[158:159], v208 offset:20480
    s_waitcnt lgkmcnt(4)
    v_mfma_f32_16x16x32_bf16 v[32:35], a[80:83], v[146:149], v[32:35]
    ds_read_b64_tr_b16 v[160:161], v208 offset:22528
    v_mfma_f32_16x16x32_bf16 v[16:19], a[16:19], v[146:149], v[16:19]
    ds_read_b64_tr_b16 a[216:217], v207 offset:24576
    v_mfma_f32_16x16x32_bf16 v[48:51], v[146:149], a[144:147], v[48:51]
    ds_read_b64_tr_b16 a[218:219], v207 offset:26624
    v_mfma_f32_16x16x32_bf16 v[64:67], v[150:153], v[150:153], v[64:67]
    ds_read_b64_tr_b16 v[162:163], v204 offset:24576
    v_mfma_f32_16x16x32_bf16 v[68:71], v[236:239], v[150:153], v[68:71]
    ds_read_b64_tr_b16 v[164:165], v204 offset:26624
    s_waitcnt lgkmcnt(5)
    v_mfma_f32_16x16x32_bf16 v[44:47], a[84:87], a[212:215], v[44:47]
    v_mfma_f32_16x16x32_bf16 v[60:63], a[212:215], a[148:151], v[60:63]
    ds_read_b64_tr_b16 v[166:167], v208 offset:24576
    v_mfma_f32_16x16x32_bf16 v[32:35], a[84:87], v[154:157], v[32:35]
    ds_read_b64_tr_b16 v[168:169], v208 offset:26624
    v_mfma_f32_16x16x32_bf16 v[16:19], a[20:23], v[154:157], v[16:19]
    ds_read_b64_tr_b16 a[220:221], v207 offset:28672
    v_mfma_f32_16x16x32_bf16 v[48:51], v[154:157], a[148:151], v[48:51]
    ds_read_b64_tr_b16 a[222:223], v207 offset:30720
    s_waitcnt lgkmcnt(4)
    v_mfma_f32_16x16x32_bf16 v[64:67], v[158:161], v[158:161], v[64:67]
    ds_read_b64_tr_b16 v[170:171], v204 offset:28672
    v_mfma_f32_16x16x32_bf16 v[68:71], v[236:239], v[158:161], v[68:71]
    ds_read_b64_tr_b16 v[172:173], v204 offset:30720
    v_mfma_f32_16x16x32_bf16 v[44:47], a[88:91], a[216:219], v[44:47]
    ds_read_b64_tr_b16 v[174:175], v208 offset:28672
    v_mfma_f32_16x16x32_bf16 v[60:63], a[216:219], a[152:155], v[60:63]
    ds_read_b64_tr_b16 v[176:177], v208 offset:30720
    v_mfma_f32_16x16x32_bf16 v[32:35], a[88:91], v[162:165], v[32:35]
    s_waitcnt vmcnt(4)
    s_barrier
    ds_read_b64_tr_b16 v[146:147], v208 offset:32768
    v_mfma_f32_16x16x32_bf16 v[16:19], a[24:27], v[162:165], v[16:19]
    ds_read_b64_tr_b16 v[148:149], v208 offset:34816
    v_mfma_f32_16x16x32_bf16 v[48:51], v[162:165], a[152:155], v[48:51]
    ds_read_b64_tr_b16 v[150:151], v208 offset:36864
    s_waitcnt lgkmcnt(5)
    v_mfma_f32_16x16x32_bf16 v[64:67], v[166:169], v[166:169], v[64:67]
    ds_read_b64_tr_b16 v[152:153], v208 offset:38912
    v_mfma_f32_16x16x32_bf16 v[68:71], v[236:239], v[166:169], v[68:71]
    ds_read_b64_tr_b16 a[224:225], v207 offset:32768
    v_mfma_f32_16x16x32_bf16 v[44:47], a[92:95], a[220:223], v[44:47]
    ds_read_b64_tr_b16 a[226:227], v207 offset:34816
    v_mfma_f32_16x16x32_bf16 v[60:63], a[220:223], a[156:159], v[60:63]
    ds_read_b64_tr_b16 v[154:155], v204 offset:32768
    v_mfma_f32_16x16x32_bf16 v[32:35], a[92:95], v[170:173], v[32:35]
    ds_read_b64_tr_b16 v[156:157], v204 offset:34816
    v_mfma_f32_16x16x32_bf16 v[16:19], a[28:31], v[170:173], v[16:19]
    ds_read_b64_tr_b16 v[158:159], v208 offset:40960
    v_mfma_f32_16x16x32_bf16 v[48:51], v[170:173], a[156:159], v[48:51]
    ds_read_b64_tr_b16 v[160:161], v208 offset:43008
    s_waitcnt lgkmcnt(5)
    v_mfma_f32_16x16x32_bf16 v[64:67], v[174:177], v[174:177], v[64:67]
    ds_read_b64_tr_b16 v[162:163], v208 offset:45056
    v_mfma_f32_16x16x32_bf16 v[68:71], v[236:239], v[174:177], v[68:71]
    ds_read_b64_tr_b16 v[164:165], v208 offset:47104
    v_mfma_f32_16x16x32_bf16 v[64:67], v[146:149], v[146:149], v[64:67]
    ds_read_b64_tr_b16 a[228:229], v207 offset:36864
    v_mfma_f32_16x16x32_bf16 v[68:71], v[236:239], v[146:149], v[68:71]
    ds_read_b64_tr_b16 a[230:231], v207 offset:38912
    v_mfma_f32_16x16x32_bf16 v[64:67], v[150:153], v[150:153], v[64:67]
    ds_read_b64_tr_b16 v[166:167], v204 offset:36864
    v_mfma_f32_16x16x32_bf16 v[68:71], v[236:239], v[150:153], v[68:71]
    ds_read_b64_tr_b16 v[168:169], v204 offset:38912
    s_waitcnt lgkmcnt(5)
    v_mfma_f32_16x16x32_bf16 v[44:47], a[96:99], a[224:227], v[44:47]
    s_waitcnt vmcnt(0)
    s_barrier
    ds_read_b64_tr_b16 v[170:171], v208 offset:49152
    s_cmp_lg_u32 s54, 0
    s_cbranch_scc1 L_nh_33
    v_mov_b32 v203, 1
    s_mov_b64 exec, 1
    buffer_atomic_add v203, v253, s[8:11], s55 offen offset:4 sc1
    s_mov_b64 exec, -1
L_nh_33:
    v_mfma_f32_16x16x32_bf16 v[60:63], a[224:227], a[160:163], v[60:63]
    ds_read_b64_tr_b16 v[172:173], v208 offset:51200
    v_mfma_f32_16x16x32_bf16 v[32:35], a[96:99], v[154:157], v[32:35]
    ds_read_b64_tr_b16 v[174:175], v208 offset:53248
    v_mfma_f32_16x16x32_bf16 v[16:19], a[32:35], v[154:157], v[16:19]
    ds_read_b64_tr_b16 v[176:177], v208 offset:55296
    v_mfma_f32_16x16x32_bf16 v[48:51], v[154:157], a[160:163], v[48:51]
    ds_read_b64_tr_b16 a[232:233], v207 offset:40960
    v_mfma_f32_16x16x32_bf16 v[64:67], v[158:161], v[158:161], v[64:67]
    ds_read_b64_tr_b16 a[234:235], v207 offset:43008
    v_mfma_f32_16x16x32_bf16 v[68:71], v[236:239], v[158:161], v[68:71]
    s_mov_b64 exec, 1
    buffer_load_dword v254, v253, s[8:11], s43 offen sc1
    s_mov_b64 exec, -1
    s_waitcnt lgkmcnt(4)
    v_mfma_f32_16x16x32_bf16 v[64:67], v[162:165], v[162:165], v[64:67]
    ds_read_b64_tr_b16 v[146:147], v208 offset:57344
    v_mfma_f32_16x16x32_bf16 v[68:71], v[236:239], v[162:165], v[68:71]
    ds_read_b64_tr_b16 v[148:149], v208 offset:59392
    v_mfma_f32_16x16x32_bf16 v[44:47], a[100:103], a[228:231], v[44:47]
    ds_read_b64_tr_b16 v[150:151], v208 offset:61440
    v_mfma_f32_16x16x32_bf16 v[60:63], a[228:231], a[164:167], v[60:63]
    ds_read_b64_tr_b16 v[152:153], v208 offset:63488
    v_mfma_f32_16x16x32_bf16 v[32:35], a[100:103], v[166:169], v[32:35]
    ds_read_b64_tr_b16 a[236:237], v207 offset:45056
    v_mfma_f32_16x16x32_bf16 v[16:19], a[36:39], v[166:169], v[16:19]
    ds_read_b64_tr_b16 a[238:239], v207 offset:47104
    v_mfma_f32_16x16x32_bf16 v[48:51], v[166:169], a[164:167], v[48:51]
    ds_read_b64_tr_b16 a[240:241], v207 offset:49152
    v_mfma_f32_16x16x32_bf16 v[64:67], v[170:173], v[170:173], v[64:67]
    ds_read_b64_tr_b16 a[242:243], v207 offset:51200
    v_mfma_f32_16x16x32_bf16 v[68:71], v[236:239], v[170:173], v[68:71]
    ds_read_b64_tr_b16 a[244:245], v207 offset:53248
    s_waitcnt lgkmcnt(5)
    v_mfma_f32_16x16x32_bf16 v[64:67], v[174:177], v[174:177], v[64:67]
    ds_read_b64_tr_b16 a[246:247], v207 offset:55296
    v_mfma_f32_16x16x32_bf16 v[68:71], v[236:239], v[174:177], v[68:71]
    ds_read_b64_tr_b16 a[248:249], v207 offset:57344
    v_mfma_f32_16x16x32_bf16 v[44:47], a[104:107], a[232:235], v[44:47]
    ds_read_b64_tr_b16 a[250:251], v207 offset:59392
    v_mfma_f32_16x16x32_bf16 v[60:63], a[232:235], a[168:171], v[60:63]
    ds_read_b64_tr_b16 a[252:253], v207 offset:61440
    v_mfma_f32_16x16x32_bf16 v[64:67], v[146:149], v[146:149], v[64:67]
    ds_read_b64_tr_b16 a[254:255], v207 offset:63488
    v_mfma_f32_16x16x32_bf16 v[68:71], v[236:239], v[146:149], v[68:71]
    ds_read_b64_tr_b16 v[88:89], v204 offset:40960
    v_mfma_f32_16x16x32_bf16 v[64:67], v[150:153], v[150:153], v[64:67]
    ds_read_b64_tr_b16 v[90:91], v204 offset:43008
    v_mfma_f32_16x16x32_bf16 v[68:71], v[236:239], v[150:153], v[68:71]
    ds_read_b64_tr_b16 v[92:93], v204 offset:45056
    s_waitcnt lgkmcnt(5)
    v_mfma_f32_16x16x32_bf16 v[44:47], a[108:111], a[236:239], v[44:47]
    ds_read_b64_tr_b16 v[94:95], v204 offset:47104
    v_mfma_f32_16x16x32_bf16 v[60:63], a[236:239], a[172:175], v[60:63]
    ds_read_b64_tr_b16 v[96:97], v204 offset:49152
    v_cndmask_b32 v180, v64, v65, s[84:85]
    v_cndmask_b32 v180, v180, v66, s[12:13]
    v_cndmask_b32 v180, v180, v67, s[14:15]
    v_cndmask_b32 v181, 0, v180, s[28:29]
    v_cndmask_b32 v180, 0, v180, s[28:29]
    v_mul_f32 v182, 0x3b000000, v68
    v_fma_f32 v184, -v182, v182, v186
    v_permlane32_swap_b32 v180, v181
    v_add_f32 v183, v180, v181
    v_add_f32 v181, v180, v181
    v_mfma_f32_16x16x32_bf16 v[44:47], a[112:115], a[240:243], v[44:47]
    ds_read_b64_tr_b16 v[98:99], v204 offset:51200
    v_permlane16_swap_b32 v183, v181
    v_add_f32 v180, v183, v181
    v_fmamk_f32 v180, v180, 0x3b000000, v184
    v_max_f32 v180, v180, v186
    v_rsq_f32 v180, v180
    v_mfma_f32_16x16x32_bf16 v[60:63], a[240:243], a[176:179], v[60:63]
    ds_read_b64_tr_b16 v[100:101], v204 offset:53248
    ds_write2_b32 v216, v180, v182 offset0:0 offset1:64
    v_mfma_f32_16x16x32_bf16 v[44:47], a[116:119], a[244:247], v[44:47]
    ds_read_b64_tr_b16 v[102:103], v204 offset:55296
    v_mfma_f32_16x16x32_bf16 v[60:63], a[244:247], a[180:183], v[60:63]
    ds_read_b64_tr_b16 v[104:105], v204 offset:57344
    v_mfma_f32_16x16x32_bf16 v[44:47], a[120:123], a[248:251], v[44:47]
    ds_read_b64_tr_b16 v[106:107], v204 offset:59392
    v_mfma_f32_16x16x32_bf16 v[60:63], a[248:251], a[184:187], v[60:63]
    ds_read_b64_tr_b16 v[108:109], v204 offset:61440
    s_waitcnt lgkmcnt(5)
    v_mfma_f32_16x16x32_bf16 v[44:47], a[124:127], a[252:255], v[44:47]
    ds_read_b64_tr_b16 v[110:111], v204 offset:63488
    v_mfma_f32_16x16x32_bf16 v[60:63], a[252:255], a[188:191], v[60:63]
    ds_read_b64_tr_b16 v[80:81], v205 offset:8192
    v_mfma_f32_16x16x32_bf16 v[32:35], a[104:107], v[88:91], v[32:35]
    ds_read_b64_tr_b16 v[82:83], v205 offset:10240
    v_mfma_f32_16x16x32_bf16 v[16:19], a[40:43], v[88:91], v[16:19]
    s_waitcnt lgkmcnt(7)
    s_barrier
    ds_read2_b32 v[144:145], v214 offset0:48 offset1:112
    ds_read2_b32 v[138:139], v214 offset0:0 offset1:64
    ds_read2_b32 v[142:143], v214 offset0:32 offset1:96
    ds_read2_b32 v[140:141], v214 offset0:16 offset1:80
    v_mfma_f32_16x16x32_bf16 v[48:51], v[88:91], a[168:171], v[48:51]
    ds_read_b64_tr_b16 v[84:85], v205 offset:12288
    ds_read_b128 v[174:177], v215 offset:448
    v_mfma_f32_16x16x32_bf16 v[32:35], a[108:111], v[92:95], v[32:35]
    ds_read_b64_tr_b16 v[86:87], v205 offset:14336
    ds_read_b128 v[170:173], v215 offset:192
    v_mfma_f32_16x16x32_bf16 v[16:19], a[44:47], v[92:95], v[16:19]
    ds_read_b128 v[166:169], v215 offset:384
    ds_read_b128 v[162:165], v215 offset:128
    v_mfma_f32_16x16x32_bf16 v[48:51], v[92:95], a[172:175], v[48:51]
    ds_read_b64_tr_b16 v[88:89], v205 offset:16384
    ds_read_b128 v[150:153], v215 offset:256
    v_mfma_f32_16x16x32_bf16 v[32:35], a[112:115], v[96:99], v[32:35]
    ds_read_b64_tr_b16 v[90:91], v205 offset:18432
    ds_read_b128 v[146:149], v215 offset:0
    v_mfma_f32_16x16x32_bf16 v[16:19], a[48:51], v[96:99], v[16:19]
    s_waitcnt lgkmcnt(8)
    v_cmp_u_f32 s[90:91], v145, v139
    v_mfma_f32_16x16x32_bf16 v[48:51], v[96:99], a[176:179], v[48:51]
    ds_read_b64_tr_b16 v[92:93], v205 offset:20480
    v_cmp_u_f32 s[76:77], v143, v141
    v_mfma_f32_16x16x32_bf16 v[32:35], a[116:119], v[100:103], v[32:35]
    ds_read_b64_tr_b16 v[94:95], v205 offset:22528
    s_or_b64 s[90:91], s[90:91], s[76:77]
    v_mfma_f32_16x16x32_bf16 v[16:19], a[52:55], v[100:103], v[16:19]
    s_and_b64 vcc, s[90:91], s[52:53]
    s_cbranch_scc1 L_qkv_redo_1
    v_mfma_f32_16x16x32_bf16 v[48:51], v[100:103], a[180:183], v[48:51]
    ds_read_b64_tr_b16 v[96:97], v205 offset:24576
    v_fma_f32 v44, -v145, v8, v44
    v_mfma_f32_16x16x32_bf16 v[32:35], a[120:123], v[104:107], v[32:35]
    ds_read_b64_tr_b16 v[98:99], v205 offset:26624
    v_fma_f32 v45, -v145, v9, v45
    v_mfma_f32_16x16x32_bf16 v[16:19], a[56:59], v[104:107], v[16:19]
    v_fma_f32 v46, -v145, v10, v46
    v_fma_f32 v47, -v145, v11, v47
    v_mfma_f32_16x16x32_bf16 v[48:51], v[104:107], a[184:187], v[48:51]
    ds_read_b64_tr_b16 v[100:101], v205 offset:28672
    v_fma_f32 v60, -v174, v12, v60
    v_mfma_f32_16x16x32_bf16 v[32:35], a[124:127], v[108:111], v[32:35]
    ds_read_b64_tr_b16 v[102:103], v205 offset:30720
    v_fma_f32 v61, -v175, v12, v61
    v_mfma_f32_16x16x32_bf16 v[16:19], a[60:63], v[108:111], v[16:19]
    v_fma_f32 v62, -v176, v12, v62
    v_fma_f32 v63, -v177, v12, v63
    v_mfma_f32_16x16x32_bf16 v[48:51], v[108:111], a[188:191], v[48:51]
    ds_read_b64_tr_b16 v[104:105], v205 offset:32768
    v_mul_f32 v44, v44, v144
    v_mfma_f32_16x16x32_bf16 v[36:39], a[72:75], v[80:83], v[36:39]
    ds_read_b64_tr_b16 v[106:107], v205 offset:34816
    v_mul_f32 v45, v45, v144
    v_mfma_f32_16x16x32_bf16 v[20:23], a[8:11], v[80:83], v[20:23]
    v_mul_f32 v46, v46, v144
    v_mul_f32 v47, v47, v144
    v_mfma_f32_16x16x32_bf16 v[52:55], v[80:83], a[136:139], v[52:55]
    ds_read_b64_tr_b16 v[108:109], v205 offset:36864
    s_waitcnt lgkmcnt(3)
    v_mfma_f32_16x16x32_bf16 v[36:39], a[76:79], v[84:87], v[36:39]
    ds_read_b64_tr_b16 v[110:111], v205 offset:38912
    v_cvt_pk_bf16_f32 v134, v44, v45
    v_mfma_f32_16x16x32_bf16 v[20:23], a[12:15], v[84:87], v[20:23]
    v_cvt_pk_bf16_f32 v135, v46, v47
    v_mul_f32 v60, v60, v170
    v_mfma_f32_16x16x32_bf16 v[52:55], v[84:87], a[140:143], v[52:55]
    ds_read_b64_tr_b16 v[80:81], v205 offset:40960
    v_mul_f32 v61, v61, v171
    v_mfma_f32_16x16x32_bf16 v[36:39], a[80:83], v[88:91], v[36:39]
    ds_read_b64_tr_b16 v[82:83], v205 offset:43008
    v_mul_f32 v62, v62, v172
    v_mfma_f32_16x16x32_bf16 v[20:23], a[16:19], v[88:91], v[20:23]
    v_mul_f32 v63, v63, v173
    v_cvt_pk_bf16_f32 v136, v60, v61
    v_mfma_f32_16x16x32_bf16 v[52:55], v[88:91], a[144:147], v[52:55]
    ds_read_b64_tr_b16 v[84:85], v205 offset:45056
    v_cvt_pk_bf16_f32 v137, v62, v63
    buffer_store_dwordx4 v[134:137], v211, s[8:11], s71 offen sc1
    v_mfma_f32_16x16x32_bf16 v[36:39], a[84:87], v[92:95], v[36:39]
    ds_read_b64_tr_b16 v[86:87], v205 offset:47104
    v_cvt_pk_bf16_f32 v132, v60, v61
    v_mfma_f32_16x16x32_bf16 v[20:23], a[20:23], v[92:95], v[20:23]
    v_cvt_pk_bf16_f32 v133, v62, v63
    ds_read_b128 v[158:161], v215 offset:320
    v_mfma_f32_16x16x32_bf16 v[52:55], v[92:95], a[148:151], v[52:55]
    ds_read_b64_tr_b16 v[88:89], v205 offset:49152
    ds_read_b128 v[154:157], v215 offset:64
    v_mfma_f32_16x16x32_bf16 v[36:39], a[88:91], v[96:99], v[36:39]
    ds_read_b64_tr_b16 v[90:91], v205 offset:51200
    v_mul_f32 v28, -v145, v4
    v_mfma_f32_16x16x32_bf16 v[20:23], a[24:27], v[96:99], v[20:23]
    v_mul_f32 v29, -v145, v5
    v_mul_f32 v30, -v145, v6
    v_mfma_f32_16x16x32_bf16 v[52:55], v[96:99], a[152:155], v[52:55]
    ds_read_b64_tr_b16 v[92:93], v205 offset:53248
    v_mul_f32 v31, -v145, v7
    v_mfma_f32_16x16x32_bf16 v[36:39], a[92:95], v[100:103], v[36:39]
    ds_read_b64_tr_b16 v[94:95], v205 offset:55296
    v_mul_f32 v40, -v143, v8
    v_mfma_f32_16x16x32_bf16 v[20:23], a[28:31], v[100:103], v[20:23]
    v_mul_f32 v41, -v143, v9
    v_mul_f32 v42, -v143, v10
    v_mfma_f32_16x16x32_bf16 v[52:55], v[100:103], a[156:159], v[52:55]
    ds_read_b64_tr_b16 v[96:97], v205 offset:57344
    s_waitcnt lgkmcnt(3)
    v_mfma_f32_16x16x32_bf16 v[36:39], a[96:99], v[104:107], v[36:39]
    ds_read_b64_tr_b16 v[98:99], v205 offset:59392
    v_mul_f32 v43, -v143, v11
    v_mfma_f32_16x16x32_bf16 v[20:23], a[32:35], v[104:107], v[20:23]
    v_mul_f32 v24, -v143, v4
    v_mul_f32 v25, -v143, v5
    v_mfma_f32_16x16x32_bf16 v[52:55], v[104:107], a[160:163], v[52:55]
    ds_read_b64_tr_b16 v[100:101], v205 offset:61440
    v_mul_f32 v26, -v143, v6
    v_mfma_f32_16x16x32_bf16 v[36:39], a[100:103], v[108:111], v[36:39]
    ds_read_b64_tr_b16 v[102:103], v205 offset:63488
    v_mul_f32 v27, -v143, v7
    v_mfma_f32_16x16x32_bf16 v[20:23], a[36:39], v[108:111], v[20:23]
    v_mul_f32 v56, -v166, v12
    v_mul_f32 v57, -v167, v12
    v_mfma_f32_16x16x32_bf16 v[52:55], v[108:111], a[164:167], v[52:55]
    v_mul_f32 v58, -v168, v12
    v_mul_f32 v59, -v169, v12
    v_mfma_f32_16x16x32_bf16 v[36:39], a[104:107], v[80:83], v[36:39]
    v_fma_f32 v32, -v139, v8, v32
    v_fma_f32 v33, -v139, v9, v33
    v_mfma_f32_16x16x32_bf16 v[20:23], a[40:43], v[80:83], v[20:23]
    v_fma_f32 v34, -v139, v10, v34
    v_fma_f32 v35, -v139, v11, v35
    v_mfma_f32_16x16x32_bf16 v[52:55], v[80:83], a[168:171], v[52:55]
    v_fma_f32 v48, -v150, v12, v48
    v_fma_f32 v49, -v151, v12, v49
    v_mfma_f32_16x16x32_bf16 v[36:39], a[108:111], v[84:87], v[36:39]
    v_fma_f32 v50, -v152, v12, v50
    v_fma_f32 v51, -v153, v12, v51
    v_mfma_f32_16x16x32_bf16 v[20:23], a[44:47], v[84:87], v[20:23]
    v_fma_f32 v16, -v139, v4, v16
    v_fma_f32 v17, -v139, v5, v17
    v_mfma_f32_16x16x32_bf16 v[52:55], v[84:87], a[172:175], v[52:55]
    v_fma_f32 v18, -v139, v6, v18
    v_fma_f32 v19, -v139, v7, v19
    v_mfma_f32_16x16x32_bf16 v[36:39], a[112:115], v[88:91], v[36:39]
    v_mul_f32 v32, v32, v138
    v_mul_f32 v33, v33, v138
    v_mfma_f32_16x16x32_bf16 v[20:23], a[48:51], v[88:91], v[20:23]
    v_mul_f32 v34, v34, v138
    v_mul_f32 v35, v35, v138
    v_mfma_f32_16x16x32_bf16 v[52:55], v[88:91], a[176:179], v[52:55]
    v_cvt_pk_bf16_f32 v116, v32, v33
    s_waitcnt lgkmcnt(0)
    v_mfma_f32_16x16x32_bf16 v[36:39], a[116:119], v[92:95], v[36:39]
    v_cvt_pk_bf16_f32 v117, v34, v35
    v_mul_f32 v48, v48, v146
    v_mfma_f32_16x16x32_bf16 v[20:23], a[52:55], v[92:95], v[20:23]
    v_mul_f32 v49, v49, v147
    v_mul_f32 v50, v50, v148
    v_mfma_f32_16x16x32_bf16 v[52:55], v[92:95], a[180:183], v[52:55]
    v_mul_f32 v51, v51, v149
    v_cvt_pk_bf16_f32 v126, v48, v49
    v_mfma_f32_16x16x32_bf16 v[36:39], a[120:123], v[96:99], v[36:39]
    v_cvt_pk_bf16_f32 v127, v50, v51
    v_mul_f32 v182, 0x3eb8aa3b, v140
    v_mfma_f32_16x16x32_bf16 v[20:23], a[56:59], v[96:99], v[20:23]
    v_mul_f32 v84, 0x3eb8aa3b, v144
    v_cvt_pk_bf16_f32 v114, v16, v17
    v_mfma_f32_16x16x32_bf16 v[52:55], v[96:99], a[184:187], v[52:55]
    v_mul_f32 v96, 0x3eb8aa3b, v142
    v_cvt_pk_bf16_f32 v115, v18, v19
    v_mfma_f32_16x16x32_bf16 v[36:39], a[124:127], v[100:103], v[36:39]
    v_mul_f32 v192, 0x3eb8aa3b, v138
    v_mfma_f32_16x16x16_bf16 v[16:19], v[116:117], v[114:115], v[220:223]
    v_mfma_f32_16x16x32_bf16 v[20:23], a[60:63], v[100:103], v[20:23]
    v_mfma_f32_16x16x32_bf16 v[52:55], v[100:103], a[188:191], v[52:55]
    v_mfma_f32_16x16x32_bf16 v[28:31], a[0:3], a[192:195], v[28:31]
    v_mfma_f32_16x16x32_bf16 v[28:31], a[4:7], a[196:199], v[28:31]
    ds_read_b64_tr_b16 a[192:193], v206 offset:0
    v_mfma_f32_16x16x32_bf16 v[28:31], a[8:11], a[200:203], v[28:31]
    ds_read_b64_tr_b16 a[194:195], v206 offset:2048
    v_fma_f32 v36, -v141, v8, v36
    v_mfma_f32_16x16x32_bf16 v[28:31], a[12:15], a[204:207], v[28:31]
    ds_read_b64_tr_b16 a[196:197], v206 offset:4096
    v_fma_f32 v37, -v141, v9, v37
    v_mfma_f32_16x16x32_bf16 v[28:31], a[16:19], a[208:211], v[28:31]
    ds_read_b64_tr_b16 a[198:199], v206 offset:6144
    v_fma_f32 v38, -v141, v10, v38
    v_mfma_f32_16x16x32_bf16 v[28:31], a[20:23], a[212:215], v[28:31]
    ds_read_b64_tr_b16 a[200:201], v206 offset:8192
    v_fma_f32 v39, -v141, v11, v39
    v_mfma_f32_16x16x32_bf16 v[28:31], a[24:27], a[216:219], v[28:31]
    ds_read_b64_tr_b16 a[202:203], v206 offset:10240
    v_fma_f32 v20, -v141, v4, v20
    v_mfma_f32_16x16x32_bf16 v[28:31], a[28:31], a[220:223], v[28:31]
    ds_read_b64_tr_b16 a[204:205], v206 offset:12288
    v_fma_f32 v21, -v141, v5, v21
    v_mfma_f32_16x16x32_bf16 v[28:31], a[32:35], a[224:227], v[28:31]
    buffer_load_dwordx4 v[122:125], v210, s[8:11], s38 offen sc1
    v_mfma_f32_16x16x32_bf16 v[28:31], a[36:39], a[228:231], v[28:31]
    ds_read_b64_tr_b16 a[206:207], v206 offset:14336
    v_fma_f32 v22, -v141, v6, v22
    v_mfma_f32_16x16x32_bf16 v[28:31], a[40:43], a[232:235], v[28:31]
    ds_read_b64_tr_b16 a[208:209], v206 offset:16384
    v_fma_f32 v23, -v141, v7, v23
    v_mfma_f32_16x16x32_bf16 v[28:31], a[44:47], a[236:239], v[28:31]
    ds_read_b64_tr_b16 a[210:211], v206 offset:18432
    v_fma_f32 v52, -v158, v12, v52
    v_mfma_f32_16x16x32_bf16 v[28:31], a[48:51], a[240:243], v[28:31]
    ds_read_b64_tr_b16 a[212:213], v206 offset:20480
    v_fma_f32 v53, -v159, v12, v53
    v_mfma_f32_16x16x32_bf16 v[28:31], a[52:55], a[244:247], v[28:31]
    ds_read_b64_tr_b16 a[214:215], v206 offset:22528
    v_fma_f32 v54, -v160, v12, v54
    v_mfma_f32_16x16x32_bf16 v[28:31], a[56:59], a[248:251], v[28:31]
    ds_read_b64_tr_b16 a[216:217], v206 offset:24576
    v_fma_f32 v55, -v161, v12, v55
    v_mfma_f32_16x16x32_bf16 v[28:31], a[60:63], a[252:255], v[28:31]
    ds_read_b64_tr_b16 a[218:219], v206 offset:26624
    s_waitcnt lgkmcnt(5)
    v_mfma_f32_16x16x32_bf16 v[40:43], a[64:67], a[192:195], v[40:43]
    ds_read_b64_tr_b16 a[220:221], v206 offset:28672
    v_mul_f32 v36, v36, v140
    v_mfma_f32_16x16x32_bf16 v[24:27], a[0:3], a[192:195], v[24:27]
    ds_read_b64_tr_b16 a[222:223], v206 offset:30720
    v_mul_f32 v37, v37, v140
    v_mfma_f32_16x16x32_bf16 v[40:43], a[68:71], a[196:199], v[40:43]
    ds_read_b64_tr_b16 a[224:225], v206 offset:32768
    v_mul_f32 v38, v38, v140
    v_mfma_f32_16x16x32_bf16 v[24:27], a[4:7], a[196:199], v[24:27]
    ds_read_b64_tr_b16 a[226:227], v206 offset:34816
    v_mul_f32 v39, v39, v140
    v_mfma_f32_16x16x32_bf16 v[40:43], a[72:75], a[200:203], v[40:43]
    ds_read_b64_tr_b16 a[228:229], v206 offset:36864
    v_cvt_pk_bf16_f32 v118, v36, v37
    v_mfma_f32_16x16x32_bf16 v[24:27], a[8:11], a[200:203], v[24:27]
    ds_read_b64_tr_b16 a[230:231], v206 offset:38912
    v_cvt_pk_bf16_f32 v119, v38, v39
    v_mfma_f32_16x16x32_bf16 v[40:43], a[76:79], a[204:207], v[40:43]
    ds_read_b64_tr_b16 a[232:233], v206 offset:40960
    v_mul_f32 v52, v52, v154
    v_mfma_f32_16x16x32_bf16 v[24:27], a[12:15], a[204:207], v[24:27]
    ds_read_b64_tr_b16 a[234:235], v206 offset:43008
    s_waitcnt lgkmcnt(5)
    v_mfma_f32_16x16x32_bf16 v[40:43], a[80:83], a[208:211], v[40:43]
    ds_read_b64_tr_b16 a[236:237], v206 offset:45056
    v_mul_f32 v53, v53, v155
    v_mfma_f32_16x16x32_bf16 v[24:27], a[16:19], a[208:211], v[24:27]
    ds_read_b64_tr_b16 a[238:239], v206 offset:47104
    v_mul_f32 v54, v54, v156
    v_mfma_f32_16x16x32_bf16 v[40:43], a[84:87], a[212:215], v[40:43]
    ds_read_b64_tr_b16 a[240:241], v206 offset:49152
    v_mul_f32 v55, v55, v157
    v_mfma_f32_16x16x32_bf16 v[24:27], a[20:23], a[212:215], v[24:27]
    ds_read_b64_tr_b16 a[242:243], v206 offset:51200
    v_cvt_pk_bf16_f32 v128, v52, v53
    v_mfma_f32_16x16x32_bf16 v[40:43], a[88:91], a[216:219], v[40:43]
    ds_read_b64_tr_b16 a[244:245], v206 offset:53248
    v_cvt_pk_bf16_f32 v129, v54, v55
    v_mfma_f32_16x16x32_bf16 v[24:27], a[24:27], a[216:219], v[24:27]
    ds_read_b64_tr_b16 a[246:247], v206 offset:55296
    v_cvt_pk_bf16_f32 v112, v20, v21
    v_mfma_f32_16x16x32_bf16 v[40:43], a[92:95], a[220:223], v[40:43]
    ds_read_b64_tr_b16 a[248:249], v206 offset:57344
    v_cvt_pk_bf16_f32 v113, v22, v23
    v_mfma_f32_16x16x32_bf16 v[24:27], a[28:31], a[220:223], v[24:27]
    ds_read_b64_tr_b16 a[250:251], v206 offset:59392
    v_mfma_f32_16x16x16_bf16 v[20:23], v[118:119], v[112:113], v[220:223]
    v_cvt_pk_bf16_f32 v90, v28, v29
    v_mfma_f32_16x16x16_bf16 v[36:39], v[116:117], v[112:113], v[224:227]
    v_cvt_pk_bf16_f32 v91, v30, v31
    s_waitcnt lgkmcnt(3)
    v_mfma_f32_16x16x32_bf16 v[40:43], a[96:99], a[224:227], v[40:43]
    ds_read_b64_tr_b16 a[252:253], v206 offset:61440
    v_max_f32 v188, v16, v17
    v_mfma_f32_16x16x16_bf16 v[28:31], v[134:135], v[90:91], v[220:223]
    v_max_f32 v178, v20, v21
    v_max_f32 v179, v22, v23
    v_mfma_f32_16x16x32_bf16 v[24:27], a[32:35], a[224:227], v[24:27]
    ds_read_b64_tr_b16 a[254:255], v206 offset:63488
    v_max3_f32 v178, v178, v36, v37
    v_mfma_f32_16x16x32_bf16 v[40:43], a[100:103], a[228:231], v[40:43]
    v_max3_f32 v179, v179, v38, v39
    v_max_f32 v180, v178, v179
    v_mfma_f32_16x16x32_bf16 v[24:27], a[36:39], a[228:231], v[24:27]
    v_max_f32 v181, v178, v179
    v_max_f32 v80, v28, v29
    v_mfma_f32_16x16x32_bf16 v[40:43], a[104:107], a[232:235], v[40:43]
    v_permlane32_swap_b32 v180, v181
    v_mfma_f32_16x16x32_bf16 v[24:27], a[40:43], a[232:235], v[24:27]
    v_max_f32 v183, v180, v181
    v_max_f32 v181, v180, v181
    v_mfma_f32_16x16x32_bf16 v[40:43], a[108:111], a[236:239], v[40:43]
    v_max_f32 v81, v30, v31
    v_max_f32 v189, v18, v19
    v_mfma_f32_16x16x32_bf16 v[24:27], a[44:47], a[236:239], v[24:27]
    v_permlane16_swap_b32 v183, v181
    v_mfma_f32_16x16x32_bf16 v[40:43], a[112:115], a[240:243], v[40:43]
    v_max_f32 v180, v183, v181
    v_mul_f32 v180, v180, v182
    v_mfma_f32_16x16x32_bf16 v[24:27], a[48:51], a[240:243], v[24:27]
    v_fma_f32 v178, v178, v182, -v180
    s_waitcnt lgkmcnt(0)
    v_mfma_f32_16x16x32_bf16 v[40:43], a[116:119], a[244:247], v[40:43]
    v_fma_f32 v179, v179, v182, -v180
    v_mfma_f32_16x16x32_bf16 v[24:27], a[52:55], a[244:247], v[24:27]
    v_exp_f32 v178, v178
    v_mfma_f32_16x16x32_bf16 v[40:43], a[120:123], a[248:251], v[40:43]
    v_exp_f32 v179, v179
    v_mfma_f32_16x16x32_bf16 v[24:27], a[56:59], a[248:251], v[24:27]
    v_cvt_pk_bf16_f32 v178, v178, v179
    v_perm_b32 v184, v178, v178, v232
    v_mfma_f32_16x16x32_bf16 v[40:43], a[124:127], a[252:255], v[40:43]
    v_perm_b32 v185, v178, v178, v233
    v_perm_b32 v186, v178, v178, v234
    v_mfma_f32_16x16x32_bf16 v[24:27], a[60:63], a[252:255], v[24:27]
    v_perm_b32 v187, v178, v178, v235
    v_mfma_f32_16x16x32_bf16 v[56:59], a[192:195], a[128:131], v[56:59]
    s_waitcnt vmcnt(0)
    v_max3_u32 v202, v122, v123, v124
    v_mfma_f32_16x16x32_bf16 v[36:39], v[236:239], v[184:187], 0
    v_mul_f32 v40, v40, v142
    v_mul_f32 v41, v41, v142
    v_mfma_f32_16x16x32_bf16 v[20:23], v[126:129], v[184:187], 0
    v_mul_f32 v42, v42, v142
    v_mul_f32 v43, v43, v142
    v_mfma_f32_16x16x32_bf16 v[56:59], a[196:199], a[132:135], v[56:59]
    v_cvt_pk_bf16_f32 v120, v40, v41
    v_cvt_pk_bf16_f32 v121, v42, v43
    v_mfma_f32_16x16x32_bf16 v[56:59], a[200:203], a[136:139], v[56:59]
    v_rcp_f32 v36, v36
    v_mfma_f32_16x16x16_bf16 v[44:47], v[120:121], v[90:91], v[224:227]
    v_mul_f32 v20, v20, v36
    v_mul_f32 v21, v21, v36
    v_mfma_f32_16x16x32_bf16 v[56:59], a[204:207], a[140:143], v[56:59]
    v_mul_f32 v22, v22, v36
    v_mul_f32 v23, v23, v36
    v_mfma_f32_16x16x32_bf16 v[56:59], a[208:211], a[144:147], v[56:59]
    v_cvt_pk_bf16_f32 v72, v20, v21
    v_cvt_pk_bf16_f32 v73, v22, v23
    v_mfma_f32_16x16x32_bf16 v[56:59], a[212:215], a[148:151], v[56:59]
    v_cvt_pk_bf16_f32 v102, v24, v25
    v_cvt_pk_bf16_f32 v103, v26, v27
    v_mfma_f32_16x16x32_bf16 v[56:59], a[216:219], a[152:155], v[56:59]
    v_max3_f32 v80, v80, v44, v45
    v_max3_f32 v81, v81, v46, v47
    v_mfma_f32_16x16x16_bf16 v[24:27], v[120:121], v[102:103], v[220:223]
    v_max_f32 v82, v80, v81
    v_max_u32 v202, v202, v125
    v_mfma_f32_16x16x16_bf16 v[40:43], v[118:119], v[102:103], v[224:227]
    v_cmp_eq_u32 vcc, -1, v202
    s_nop 0
    s_or_b64 vcc, vcc, vcc
    s_cbranch_scc1 L_hx_31
L_hxb_32:
    v_mfma_f32_16x16x16_bf16 v[32:35], v[122:123], v[114:115], v[228:231]
    v_max_f32 v92, v24, v25
    v_max_f32 v93, v26, v27
    v_mfma_f32_16x16x32_bf16 v[56:59], a[220:223], a[156:159], v[56:59]
    v_max3_f32 v92, v92, v40, v41
    v_max3_f32 v93, v93, v42, v43
    v_mfma_f32_16x16x32_bf16 v[56:59], a[224:227], a[160:163], v[56:59]
    v_max_f32 v94, v92, v93
    v_mfma_f32_16x16x32_bf16 v[56:59], a[228:231], a[164:167], v[56:59]
    v_max3_f32 v188, v188, v32, v33
    v_max3_f32 v189, v189, v34, v35
    v_mfma_f32_16x16x32_bf16 v[56:59], a[232:235], a[168:171], v[56:59]
    v_max_f32 v190, v188, v189
L_warm_1_0_1:
    s_cbranch_execz L_wret_1
    v_max_f32 v191, v188, v189
    v_mfma_f32_16x16x32_bf16 v[56:59], a[236:239], a[172:175], v[56:59]
    v_permlane32_swap_b32 v94, v82
    v_mfma_f32_16x16x32_bf16 v[56:59], a[240:243], a[176:179], v[56:59]
    v_permlane32_swap_b32 v190, v191
    v_mfma_f32_16x16x32_bf16 v[56:59], a[244:247], a[180:183], v[56:59]
    v_max_f32 v95, v94, v82
    v_max_f32 v193, v190, v191
    v_mfma_f32_16x16x32_bf16 v[56:59], a[248:251], a[184:187], v[56:59]
    v_max_f32 v83, v94, v82
    v_max_f32 v191, v190, v191
    v_mfma_f32_16x16x32_bf16 v[56:59], a[252:255], a[188:191], v[56:59]
    v_permlane16_swap_b32 v95, v83
    v_permlane16_swap_b32 v193, v191
    v_max_f32 v94, v95, v83
    v_max_f32 v190, v193, v191
    v_max_f32 v82, v95, v83
    v_mul_f32 v190, v190, v192
    v_fma_f32 v188, v188, v192, -v190
    v_permlane32_swap_b32 v94, v82
    v_mul_f32 v94, v94, v96
    v_mul_f32 v82, v82, v84
    v_fma_f32 v92, v92, v96, -v94
    v_fma_f32 v80, v80, v84, -v82
    v_fma_f32 v93, v93, v96, -v94
    v_fma_f32 v81, v81, v84, -v82
    v_fma_f32 v189, v189, v192, -v190
    v_exp_f32 v92, v92
    v_exp_f32 v80, v80
    v_exp_f32 v188, v188
    v_exp_f32 v93, v93
    v_exp_f32 v81, v81
    v_exp_f32 v189, v189
    v_cvt_pk_bf16_f32 v92, v92, v93
    v_cvt_pk_bf16_f32 v80, v80, v81
    v_cvt_pk_bf16_f32 v188, v188, v189
    v_perm_b32 v98, v92, v92, v232
    v_perm_b32 v86, v80, v80, v232
    v_perm_b32 v194, v188, v188, v232
    v_perm_b32 v99, v92, v92, v233
    v_perm_b32 v87, v80, v80, v233
    v_perm_b32 v195, v188, v188, v233
    v_perm_b32 v100, v92, v92, v234
    v_perm_b32 v88, v80, v80, v234
    v_perm_b32 v196, v188, v188, v234
    v_perm_b32 v101, v92, v92, v235
    v_perm_b32 v89, v80, v80, v235
    v_perm_b32 v197, v188, v188, v235
    v_mfma_f32_16x16x32_bf16 v[40:43], v[236:239], v[98:101], 0
    v_mfma_f32_16x16x32_bf16 v[44:47], v[236:239], v[86:89], 0
    v_mfma_f32_16x16x32_bf16 v[32:35], v[236:239], v[194:197], 0
    v_pk_mul_f32 v[56:57], v[56:57], v[162:163]
    v_mfma_f32_16x16x32_bf16 v[16:19], v[124:127], v[194:197], 0
    v_pk_mul_f32 v[58:59], v[58:59], v[164:165]
    v_cvt_pk_bf16_f32 v130, v56, v57
    v_cvt_pk_bf16_f32 v131, v58, v59
    s_nop 1
    v_mfma_f32_16x16x32_bf16 v[24:27], v[128:131], v[98:101], 0
    v_mfma_f32_16x16x32_bf16 v[28:31], v[130:133], v[86:89], 0
    v_rcp_f32 v40, v40
    v_rcp_f32 v44, v44
    v_rcp_f32 v32, v32
    s_nop 3
    v_pk_mul_f32 v[24:25], v[24:25], v[40:41] op_sel:[0,0] op_sel_hi:[1,0]
    v_pk_mul_f32 v[28:29], v[28:29], v[44:45] op_sel:[0,0] op_sel_hi:[1,0]
    v_pk_mul_f32 v[16:17], v[16:17], v[32:33] op_sel:[0,0] op_sel_hi:[1,0]
    v_pk_mul_f32 v[26:27], v[26:27], v[40:41] op_sel:[0,0] op_sel_hi:[1,0]
    v_pk_mul_f32 v[30:31], v[30:31], v[44:45] op_sel:[0,0] op_sel_hi:[1,0]
    v_pk_mul_f32 v[18:19], v[18:19], v[32:33] op_sel:[0,0] op_sel_hi:[1,0]
    v_cvt_pk_bf16_f32 v74, v24, v25
    v_cvt_pk_bf16_f32 v78, v28, v29
    v_cvt_pk_bf16_f32 v76, v16, v17
    v_cvt_pk_bf16_f32 v75, v26, v27
    v_cvt_pk_bf16_f32 v79, v30, v31
    v_cvt_pk_bf16_f32 v77, v18, v19
    v_permlane16_swap_b32 v72, v74
    v_permlane16_swap_b32 v73, v75
    s_cmp_lg_u32 s101, 0
    s_cbranch_scc1 L_sg_34
    buffer_store_dwordx4 v[72:75], v212, s[8:11], s42 offen
L_sb_35:
    v_permlane16_swap_b32 v76, v78
    v_permlane16_swap_b32 v77, v79
    s_cmp_lg_u32 s101, 0
    s_cbranch_scc1 L_sg_36
    buffer_store_dwordx4 v[76:79], v213, s[8:11], s41 offen
L_sb_37:
    v_add_u32 v196, 98304, v211
    s_lshl2_add_u32 s72, s66, s33
    s_lshl1_add_u32 s72, s72, s43
    v_mov_b32 v203, 1
    v_lshlrev_b32 v201, 2, v1
    ds_read_b128 a[192:195], v196 offset:0
    ds_read_b128 a[196:199], v196 offset:1024
    ds_read_b128 a[200:203], v196 offset:2048
    ds_read_b128 a[204:207], v196 offset:3072
    ds_read_b128 a[208:211], v196 offset:4096
    ds_read_b128 a[212:215], v196 offset:5120
    ds_read_b128 a[216:219], v196 offset:6144
    ds_read_b128 a[220:223], v196 offset:7168
    ds_read_b128 a[224:227], v196 offset:8192
    ds_read_b128 a[228:231], v196 offset:9216
    s_waitcnt vmcnt(0)
    s_mov_b64 exec, 1
    s_cmp_lg_u32 s101, 0
    s_cbranch_scc1 L_sg_38
    buffer_store_short v203, v253, s[8:11], s72 offen
L_sb_39:
    s_mov_b64 exec, -1
    v_add_u32 v200, s50, v208
    ds_read_b64_tr_b16 v[32:33], v200 offset:0
    ds_read_b64_tr_b16 v[34:35], v200 offset:2048
    ds_read_b64_tr_b16 v[36:37], v200 offset:4096
    ds_read_b64_tr_b16 v[38:39], v200 offset:6144
    s_add_u32 s45, s44, 32896
    s_add_u32 s46, s44, 65792
    s_add_u32 s47, s44, 98688
    s_mov_b64 exec, 0xffff
    buffer_load_dword v203, v201, s[8:11], s43 offen sc1
    s_mov_b64 exec, -1
    ds_read_b128 a[232:235], v196 offset:10240
    ds_read_b128 a[236:239], v196 offset:11264
    ds_read_b128 a[240:243], v196 offset:12288
    ds_read_b128 a[244:247], v196 offset:13312
    ds_read_b128 a[248:251], v196 offset:14336
    ds_read_b128 a[252:255], v196 offset:15360
    ds_read_b128 v[104:107], v196 offset:16384
    ds_read_b128 v[108:111], v196 offset:17408
    s_waitcnt lgkmcnt(11)
    v_lshlrev_b32 v16, 16, v32
    v_and_b32 v17, 0xffff0000, v32
    v_lshlrev_b32 v18, 16, v33
    v_and_b32 v19, 0xffff0000, v33
    s_waitcnt lgkmcnt(8)
    v_lshlrev_b32 v20, 16, v34
    v_and_b32 v21, 0xffff0000, v34
    v_lshlrev_b32 v22, 16, v35
    v_and_b32 v23, 0xffff0000, v35
    v_lshlrev_b32 v24, 16, v36
    v_and_b32 v25, 0xffff0000, v36
    v_lshlrev_b32 v26, 16, v37
    v_and_b32 v27, 0xffff0000, v37
    v_lshlrev_b32 v28, 16, v38
    v_and_b32 v29, 0xffff0000, v38
    v_lshlrev_b32 v30, 16, v39
    v_and_b32 v31, 0xffff0000, v39
    s_mov_b64 exec, 0xffff
    s_mov_b32 s80, 0
    s_mov_b32 s73, 0x10001
    s_waitcnt vmcnt(0)
L_lp_40:
    v_cmp_ne_u32 vcc, s73, v203
    s_nop 0
    s_and_b64 exec, exec, vcc
    s_cbranch_scc0 L_lpx_41
    buffer_load_dword v203, v201, s[8:11], s43 offen sc1
    s_add_u32 s80, s80, 1
    s_cmp_lt_u32 s80, 400000
    s_waitcnt vmcnt(0)
    s_cbranch_scc1 L_lp_40
L_lpx_41:
    s_mov_b64 exec, -1
    buffer_load_dwordx4 v[40:43], v211, s[8:11], s44 offen offset:0 sc1
    buffer_load_dwordx4 v[44:47], v211, s[8:11], s44 offen offset:1024 sc1
    buffer_load_dwordx4 v[48:51], v211, s[8:11], s44 offen offset:2048 sc1
    buffer_load_dwordx4 v[52:55], v211, s[8:11], s44 offen offset:3072 sc1
    buffer_load_dwordx4 v[56:59], v211, s[8:11], s45 offen offset:0 sc1
    buffer_load_dwordx4 v[60:63], v211, s[8:11], s45 offen offset:1024 sc1
    ds_read_b128 v[112:115], v196 offset:18432
    ds_read_b128 v[116:119], v196 offset:19456
    ds_read_b128 v[120:123], v196 offset:20480
    ds_read_b128 v[124:127], v196 offset:21504
    ds_read_b128 v[128:131], v196 offset:22528
    ds_read_b128 v[132:135], v196 offset:23552
    ds_read_b128 v[136:139], v196 offset:24576
    ds_read_b128 v[140:143], v196 offset:25600
    v_and_b32 v200, 1, v3
    v_lshlrev_b32 v200, 5, v200
    v_lshrrev_b32 v201, 1, v3
    v_lshl_add_u32 v200, v201, 4, v200
    v_lshl_add_u32 v200, v2, 10, v200
    s_waitcnt vmcnt(5)
    v_mfma_f32_16x16x32_bf16 v[16:19], a[192:195], v[40:43], v[16:19]
    ds_read_b128 v[144:147], v196 offset:26624
    v_mfma_f32_16x16x32_bf16 v[20:23], a[196:199], v[40:43], v[20:23]
    buffer_load_dwordx4 v[64:67], v211, s[8:11], s45 offen offset:2048 sc1
    v_mfma_f32_16x16x32_bf16 v[24:27], a[200:203], v[40:43], v[24:27]
    ds_read_b128 v[148:151], v196 offset:27648
    v_mfma_f32_16x16x32_bf16 v[28:31], a[204:207], v[40:43], v[28:31]
    ds_read_b128 v[152:155], v196 offset:28672
    s_waitcnt vmcnt(5)
    v_mfma_f32_16x16x32_bf16 v[16:19], a[208:211], v[44:47], v[16:19]
    ds_read_b128 v[156:159], v196 offset:29696
    v_mfma_f32_16x16x32_bf16 v[20:23], a[212:215], v[44:47], v[20:23]
    buffer_load_dwordx4 v[68:71], v211, s[8:11], s45 offen offset:3072 sc1
    v_mfma_f32_16x16x32_bf16 v[24:27], a[216:219], v[44:47], v[24:27]
    ds_read_b128 v[160:163], v196 offset:30720
    v_mfma_f32_16x16x32_bf16 v[28:31], a[220:223], v[44:47], v[28:31]
    ds_read_b128 v[164:167], v196 offset:31744
    s_waitcnt vmcnt(5)
    v_mfma_f32_16x16x32_bf16 v[16:19], a[224:227], v[48:51], v[16:19]
    ds_read_b128 v[168:171], v196 offset:32768
    v_mfma_f32_16x16x32_bf16 v[20:23], a[228:231], v[48:51], v[20:23]
    buffer_load_dwordx4 v[72:75], v211, s[8:11], s46 offen offset:0 sc1
    s_waitcnt lgkmcnt(3)
    v_mfma_f32_16x16x32_bf16 v[24:27], a[232:235], v[48:51], v[24:27]
    ds_read_b128 v[172:175], v196 offset:33792
    v_mfma_f32_16x16x32_bf16 v[28:31], a[236:239], v[48:51], v[28:31]
    ds_read_b128 v[176:179], v196 offset:34816
    s_waitcnt vmcnt(5)
    v_mfma_f32_16x16x32_bf16 v[16:19], a[240:243], v[52:55], v[16:19]
    ds_read_b128 v[180:183], v196 offset:35840
    v_mfma_f32_16x16x32_bf16 v[20:23], a[244:247], v[52:55], v[20:23]
    buffer_load_dwordx4 v[76:79], v211, s[8:11], s46 offen offset:1024 sc1
    v_mfma_f32_16x16x32_bf16 v[24:27], a[248:251], v[52:55], v[24:27]
    ds_read_b128 v[184:187], v196 offset:36864
    v_mfma_f32_16x16x32_bf16 v[28:31], a[252:255], v[52:55], v[28:31]
    ds_read_b128 v[188:191], v196 offset:37888
    s_waitcnt vmcnt(5)
    v_mfma_f32_16x16x32_bf16 v[16:19], v[104:107], v[56:59], v[16:19]
    ds_read_b128 v[192:195], v196 offset:38912
    v_mfma_f32_16x16x32_bf16 v[20:23], v[108:111], v[56:59], v[20:23]
    buffer_load_dwordx4 v[80:83], v211, s[8:11], s46 offen offset:2048 sc1
    v_mfma_f32_16x16x32_bf16 v[24:27], v[112:115], v[56:59], v[24:27]
    ds_read_b128 a[192:195], v196 offset:39936
    v_mfma_f32_16x16x32_bf16 v[28:31], v[116:119], v[56:59], v[28:31]
    ds_read_b128 a[196:199], v196 offset:40960
    s_waitcnt vmcnt(5)
    v_mfma_f32_16x16x32_bf16 v[16:19], v[120:123], v[60:63], v[16:19]
    ds_read_b128 a[200:203], v196 offset:41984
    v_mfma_f32_16x16x32_bf16 v[20:23], v[124:127], v[60:63], v[20:23]
    buffer_load_dwordx4 v[84:87], v211, s[8:11], s46 offen offset:3072 sc1
    v_mfma_f32_16x16x32_bf16 v[24:27], v[128:131], v[60:63], v[24:27]
    ds_read_b128 a[204:207], v196 offset:43008
    v_mfma_f32_16x16x32_bf16 v[28:31], v[132:135], v[60:63], v[28:31]
    ds_read_b128 a[208:211], v196 offset:44032
    s_waitcnt vmcnt(5)
    v_mfma_f32_16x16x32_bf16 v[16:19], v[136:139], v[64:67], v[16:19]
    ds_read_b128 a[212:215], v196 offset:45056
    v_mfma_f32_16x16x32_bf16 v[20:23], v[140:143], v[64:67], v[20:23]
    buffer_load_dwordx4 v[88:91], v211, s[8:11], s47 offen offset:0 sc1
    v_mfma_f32_16x16x32_bf16 v[24:27], v[144:147], v[64:67], v[24:27]
    ds_read_b128 a[216:219], v196 offset:46080
    v_mfma_f32_16x16x32_bf16 v[28:31], v[148:151], v[64:67], v[28:31]
    ds_read_b128 a[220:223], v196 offset:47104
    s_waitcnt vmcnt(5)
    v_mfma_f32_16x16x32_bf16 v[16:19], v[152:155], v[68:71], v[16:19]
    ds_read_b128 a[224:227], v196 offset:48128
    v_mfma_f32_16x16x32_bf16 v[20:23], v[156:159], v[68:71], v[20:23]
    buffer_load_dwordx4 v[92:95], v211, s[8:11], s47 offen offset:1024 sc1
    s_waitcnt lgkmcnt(3)
    v_mfma_f32_16x16x32_bf16 v[24:27], v[160:163], v[68:71], v[24:27]
    ds_read_b128 a[228:231], v196 offset:49152
    v_mfma_f32_16x16x32_bf16 v[28:31], v[164:167], v[68:71], v[28:31]
    ds_read_b128 a[232:235], v196 offset:50176
    s_waitcnt vmcnt(5)
    v_mfma_f32_16x16x32_bf16 v[16:19], v[168:171], v[72:75], v[16:19]
    ds_read_b128 a[236:239], v196 offset:51200
    v_mfma_f32_16x16x32_bf16 v[20:23], v[172:175], v[72:75], v[20:23]
    buffer_load_dwordx4 v[96:99], v211, s[8:11], s47 offen offset:2048 sc1
    v_mfma_f32_16x16x32_bf16 v[24:27], v[176:179], v[72:75], v[24:27]
    ds_read_b128 a[240:243], v196 offset:52224
    v_mfma_f32_16x16x32_bf16 v[28:31], v[180:183], v[72:75], v[28:31]
    ds_read_b128 a[244:247], v196 offset:53248
    s_waitcnt vmcnt(5)
    v_mfma_f32_16x16x32_bf16 v[16:19], v[184:187], v[76:79], v[16:19]
    ds_read_b128 a[248:251], v196 offset:54272
    v_mfma_f32_16x16x32_bf16 v[20:23], v[188:191], v[76:79], v[20:23]
    buffer_load_dwordx4 v[100:103], v211, s[8:11], s47 offen offset:3072 sc1
    v_mfma_f32_16x16x32_bf16 v[24:27], v[192:195], v[76:79], v[24:27]
    ds_read_b128 a[252:255], v196 offset:55296
    v_mfma_f32_16x16x32_bf16 v[28:31], a[192:195], v[76:79], v[28:31]
    ds_read_b128 v[104:107], v196 offset:56320
    s_waitcnt vmcnt(5)
    v_mfma_f32_16x16x32_bf16 v[16:19], a[196:199], v[80:83], v[16:19]
    ds_read_b128 v[108:111], v196 offset:57344
    v_mfma_f32_16x16x32_bf16 v[20:23], a[200:203], v[80:83], v[20:23]
    ds_read_b128 v[112:115], v196 offset:58368
    v_mfma_f32_16x16x32_bf16 v[24:27], a[204:207], v[80:83], v[24:27]
    ds_read_b128 v[116:119], v196 offset:59392
    v_mfma_f32_16x16x32_bf16 v[28:31], a[208:211], v[80:83], v[28:31]
    ds_read_b128 v[120:123], v196 offset:60416
    s_waitcnt vmcnt(4)
    v_mfma_f32_16x16x32_bf16 v[16:19], a[212:215], v[84:87], v[16:19]
    ds_read_b128 v[124:127], v196 offset:61440
    s_waitcnt lgkmcnt(5)
    v_mfma_f32_16x16x32_bf16 v[20:23], a[216:219], v[84:87], v[20:23]
    ds_read_b128 v[128:131], v196 offset:62464
    v_mfma_f32_16x16x32_bf16 v[24:27], a[220:223], v[84:87], v[24:27]
    ds_read_b128 v[132:135], v196 offset:63488
    v_mfma_f32_16x16x32_bf16 v[28:31], a[224:227], v[84:87], v[28:31]
    ds_read_b128 v[136:139], v196 offset:64512
    s_waitcnt vmcnt(3)
    v_mfma_f32_16x16x32_bf16 v[16:19], a[228:231], v[88:91], v[16:19]
    v_mfma_f32_16x16x32_bf16 v[20:23], a[232:235], v[88:91], v[20:23]
    v_mfma_f32_16x16x32_bf16 v[24:27], a[236:239], v[88:91], v[24:27]
    v_mfma_f32_16x16x32_bf16 v[28:31], a[240:243], v[88:91], v[28:31]
    s_waitcnt vmcnt(2)
    v_mfma_f32_16x16x32_bf16 v[16:19], a[244:247], v[92:95], v[16:19]
    v_mfma_f32_16x16x32_bf16 v[20:23], a[248:251], v[92:95], v[20:23]
    v_mfma_f32_16x16x32_bf16 v[24:27], a[252:255], v[92:95], v[24:27]
    v_mfma_f32_16x16x32_bf16 v[28:31], v[104:107], v[92:95], v[28:31]
    s_waitcnt vmcnt(1) lgkmcnt(0)
    v_mfma_f32_16x16x32_bf16 v[16:19], v[108:111], v[96:99], v[16:19]
    v_mfma_f32_16x16x32_bf16 v[20:23], v[112:115], v[96:99], v[20:23]
    v_mfma_f32_16x16x32_bf16 v[24:27], v[116:119], v[96:99], v[24:27]
    v_mfma_f32_16x16x32_bf16 v[28:31], v[120:123], v[96:99], v[28:31]
    s_waitcnt vmcnt(0)
    v_mfma_f32_16x16x32_bf16 v[16:19], v[124:127], v[100:103], v[16:19]
    v_mfma_f32_16x16x32_bf16 v[20:23], v[128:131], v[100:103], v[20:23]
    v_mfma_f32_16x16x32_bf16 v[24:27], v[132:135], v[100:103], v[24:27]
    v_mfma_f32_16x16x32_bf16 v[28:31], v[136:139], v[100:103], v[28:31]
    s_nop 4
    v_cvt_pk_bf16_f32 v32, v16, v17
    v_cvt_pk_bf16_f32 v33, v18, v19
    v_cvt_pk_bf16_f32 v34, v20, v21
    v_cvt_pk_bf16_f32 v35, v22, v23
    s_nop 0
    v_permlane16_swap_b32 v32, v34
    v_permlane16_swap_b32 v33, v35
    buffer_store_dwordx4 v[32:35], v200, s[24:27], s51 offen offset:0
    v_cvt_pk_bf16_f32 v36, v24, v25
    v_cvt_pk_bf16_f32 v37, v26, v27
    v_cvt_pk_bf16_f32 v38, v28, v29
    v_cvt_pk_bf16_f32 v39, v30, v31
    s_nop 0
    v_permlane16_swap_b32 v36, v38
    v_permlane16_swap_b32 v37, v39
    buffer_store_dwordx4 v[36:39], v200, s[24:27], s51 offen offset:64
L_end:
    s_endpgm
L_warm_1_0:
    s_branch L_warm_1_0_1
L_poll_10:
    s_mov_b32 s80, 0
L_pl_42:
    v_mov_b32 v219, 0
    buffer_atomic_add v219, v253, s[8:11], s99 offen sc0 sc1
    s_waitcnt vmcnt(0)
    v_cmp_ne_u32 vcc, 16, v219
    s_nop 0
    s_and_b64 exec, exec, vcc
    s_cbranch_scc0 L_pollx_11
    s_add_u32 s80, s80, 1
    s_cmp_lt_u32 s80, 200000
    s_cbranch_scc1 L_pl_42
    s_branch L_pollx_11
L_qkv_redo_0:
    s_waitcnt vmcnt(0) lgkmcnt(0)
    s_mov_b64 s[52:53], 0
    s_mov_b32 s54, 1
    s_mov_b32 s72, 32768
    s_cmp_lg_u32 s33, 0
    s_cbranch_scc1 L_skip_43
    s_mov_b64 exec, 0xffff
    s_mov_b32 s80, 0
L_hp_44:
    v_mov_b32 v203, 0
    buffer_atomic_add v203, v253, s[8:11], s72 offen offset:4 sc0 sc1
    s_add_u32 s80, s80, 1
    s_waitcnt vmcnt(0)
    v_cmp_ne_u32 vcc, 16, v203
    s_nop 0
    s_and_b64 exec, exec, vcc
    s_cbranch_scc0 L_hpx_45
    s_cmp_lt_u32 s80, 400000
    s_cbranch_scc1 L_hp_44
L_hpx_45:
    s_mov_b64 exec, -1
L_skip_43:
    s_nop 7
    s_nop 7
    s_barrier
    s_branch L_qkv_again_0
L_warm_1_1:
    s_branch L_wret_1
L_hx_12:
    s_mov_b32 s80, 0
L_hl_46:
    buffer_load_dwordx4 v[122:125], v210, s[8:11], s38 offen sc1
    s_add_u32 s80, s80, 1
    s_waitcnt vmcnt(0)
    v_max3_u32 v202, v122, v123, v124
    v_max_u32 v202, v202, v125
    v_cmp_eq_u32 vcc, -1, v202
    s_nop 0
    s_or_b64 vcc, vcc, vcc
    s_cbranch_scc0 L_hxb_13
    s_cmp_lt_u32 s80, 200000
    s_cbranch_scc1 L_hl_46
    s_branch L_hxb_13
L_wvo_15:
    s_waitcnt lgkmcnt(0)
    s_branch L_wv_14
L_sg_17:
    s_nop 4
    buffer_store_dwordx4 v[72:75], v212, s[8:11], s42 offen sc1
    s_nop 1
    s_branch L_sb_18
L_sg_19:
    s_nop 4
    buffer_store_dwordx4 v[76:79], v213, s[8:11], s41 offen sc1
    s_nop 1
    s_branch L_sb_20
L_sg_21:
    s_nop 4
    buffer_store_short v203, v253, s[8:11], s72 offen sc1
    s_nop 1
    s_branch L_sb_22
L_warm_2_0:
    s_branch L_wret_2
L_poll_25:
    s_mov_b32 s80, 0
L_pl_47:
    v_mov_b32 v219, 0
    buffer_atomic_add v219, v253, s[8:11], s99 offen sc0 sc1
    s_waitcnt vmcnt(0)
    v_cmp_ne_u32 vcc, 16, v219
    s_nop 0
    s_and_b64 exec, exec, vcc
    s_cbranch_scc0 L_pollx_26
    s_add_u32 s80, s80, 1
    s_cmp_lt_u32 s80, 200000
    s_cbranch_scc1 L_pl_47
    s_branch L_pollx_26
L_warm_2_1:
    s_branch L_wret_2
L_poll_27:
    s_mov_b32 s80, 0
L_pl_48:
    v_mov_b32 v219, 0
    buffer_atomic_add v219, v253, s[8:11], s99 offen sc0 sc1
    s_waitcnt vmcnt(0)
    v_cmp_ne_u32 vcc, 16, v219
    s_nop 0
    s_and_b64 exec, exec, vcc
    s_cbranch_scc0 L_pollx_28
    s_add_u32 s80, s80, 1
    s_cmp_lt_u32 s80, 200000
    s_cbranch_scc1 L_pl_48
    s_branch L_pollx_28
L_warm_2_2:
    s_branch L_wret_2
L_poll_29:
    s_mov_b32 s80, 0
L_pl_49:
    v_mov_b32 v219, 0
    buffer_atomic_add v219, v253, s[8:11], s99 offen sc0 sc1
    s_waitcnt vmcnt(0)
    v_cmp_ne_u32 vcc, 16, v219
    s_nop 0
    s_and_b64 exec, exec, vcc
    s_cbranch_scc0 L_pollx_30
    s_add_u32 s80, s80, 1
    s_cmp_lt_u32 s80, 200000
    s_cbranch_scc1 L_pl_49
    s_branch L_pollx_30
L_qkv_redo_1:
    s_waitcnt vmcnt(0) lgkmcnt(0)
    s_mov_b64 s[52:53], 0
    s_mov_b32 s54, 1
    s_mov_b32 s72, 98304
    s_cmp_lg_u32 s33, 0
    s_cbranch_scc1 L_skip_50
    s_mov_b64 exec, 0xffff
    s_mov_b32 s80, 0
L_hp_51:
    v_mov_b32 v203, 0
    buffer_atomic_add v203, v253, s[8:11], s72 offen offset:4 sc0 sc1
    s_add_u32 s80, s80, 1
    s_waitcnt vmcnt(0)
    v_cmp_ne_u32 vcc, 16, v203
    s_nop 0
    s_and_b64 exec, exec, vcc
    s_cbranch_scc0 L_hpx_52
    s_cmp_lt_u32 s80, 400000
    s_cbranch_scc1 L_hp_51
L_hpx_52:
    s_mov_b64 exec, -1
L_skip_50:
    s_nop 7
    s_nop 7
    s_barrier
    s_branch L_qkv_again_1
L_warm_2_3:
    s_branch L_wret_2
L_hx_31:
    s_mov_b32 s80, 0
L_hl_53:
    buffer_load_dwordx4 v[122:125], v210, s[8:11], s38 offen sc1
    s_add_u32 s80, s80, 1
    s_waitcnt vmcnt(0)
    v_max3_u32 v202, v122, v123, v124
    v_max_u32 v202, v202, v125
    v_cmp_eq_u32 vcc, -1, v202
    s_nop 0
    s_or_b64 vcc, vcc, vcc
    s_cbranch_scc0 L_hxb_32
    s_cmp_lt_u32 s80, 200000
    s_cbranch_scc1 L_hl_53
    s_branch L_hxb_32
L_sg_34:
    s_nop 4
    buffer_store_dwordx4 v[72:75], v212, s[8:11], s42 offen sc1
    s_nop 1
    s_branch L_sb_35
L_sg_36:
    s_nop 4
    buffer_store_dwordx4 v[76:79], v213, s[8:11], s41 offen sc1
    s_nop 1
    s_branch L_sb_37
L_sg_38:
    s_nop 4
    buffer_store_short v203, v253, s[8:11], s72 offen sc1
    s_nop 1
    s_branch L_sb_39
.p2align 12
.type L_table,@object
L_table:
.short 9470, 9454, 9438, 9422, 9406, 9390, 9374, 9358, 9468, 9452, 9436, 9420, 9404, 9388, 9372, 9356
.short 9466, 9450, 9434, 9418, 9402, 9386, 9370, 9354, 9464, 9448, 9432, 9416, 9400, 9384, 9368, 9352
.short 9342, 9326, 9310, 9294, 9278, 9262, 9246, 9230, 9340, 9324, 9308, 9292, 9276, 9260, 9244, 9228
.short 9338, 9322, 9306, 9290, 9274, 9258, 9242, 9226, 9336, 9320, 9304, 9288, 9272, 9256, 9240, 9224
.short 12288, 12288, 12288, 12288, 12288, 12288, 12288, 12288, 12288, 12288, 12288, 12288, 12288, 12288, 12288, 12288
.short 12288, 12288, 12288, 12288, 12288, 12288, 12288, 12288, 12288, 12288, 12288, 12288, 12288, 12288, 12288, 12288
.short 12288, 12288, 12288, 12288, 12288, 12288, 12288, 12288, 12288, 12288, 12288, 12288, 12288, 12288, 12288, 12288
.short 12288, 12288, 12288, 12288, 12288, 12288, 12288, 12288, 12288, 12288, 12288, 12288, 12288, 12288, 12288, 12288
.short 9472, 9462, 9446, 9430, 9414, 9398, 9382, 9366, 9350, 9460, 9444, 9428, 9412, 9396, 9380, 9364
.short 9348, 9458, 9442, 9426, 9410, 9394, 9378, 9362, 9346, 9456, 9440, 9424, 9408, 9392, 9376, 9360
.short 9344, 9334, 9318, 9302, 9286, 9270, 9254, 9238, 9222, 9332, 9316, 9300, 9284, 9268, 9252, 9236
.short 9220, 9330, 9314, 9298, 9282, 9266, 9250, 9234, 9218, 9328, 9312, 9296, 9280, 9264, 9248, 9232
.short 12288, 12288, 12288, 12288, 12288, 12288, 12288, 12288, 12288, 12288, 12288, 12288, 12288, 12288, 12288, 12288
.short 12288, 12288, 12288, 12288, 12288, 12288, 12288, 12288, 12288, 12288, 12288, 12288, 12288, 12288, 12288, 12288
.short 12288, 12288, 12288, 12288, 12288, 12288, 12288, 12288, 12288, 12288, 12288, 12288, 12288, 12288, 12288, 12288
.short 12288, 12288, 12288, 12288, 12288, 12288, 12288, 12288, 12288, 12288, 12288, 12288, 12288, 12288, 12288, 12288
.short 12288, 12288, 12288, 12288, 12288, 12288, 12288, 12288, 12288, 12288, 12288, 12288, 12288, 12288, 12288, 12288
.short 12288, 12288, 12288, 12288, 12288, 12288, 12288, 12288, 12288, 12288, 12288, 12288, 12288, 12288, 12288, 12288
.short 12288, 12288, 12288, 12288, 12288, 12288, 12288, 12288, 12288, 12288, 12288, 12288, 12288, 12288, 12288, 12288
.short 12288, 12288, 12288, 12288, 12288, 12288, 12288, 12288, 12288, 12288, 12288, 12288, 12288, 12288, 12288, 12288
.short 12288, 12288, 12288, 12288, 12288, 12288, 12288, 12288, 12288, 12288, 12288, 12288, 12288, 12288, 12288, 12288
.short 12288, 12288, 12288, 12288, 12288, 12288, 12288, 12288, 12288, 12288, 12288, 12288, 12288, 12288, 12288, 12288
.short 12288, 12288, 12288, 12288, 12288, 12288, 12288, 12288, 12288, 12288, 12288, 12288, 12288, 12288, 12288, 12288
.short 12288, 12288, 12288, 12288, 12288, 12288, 12288, 12288, 12288, 12288, 12288, 12288, 12288, 12288, 12288, 12288
.short 12288, 12288, 12288, 12288, 12288, 12288, 12288, 12288, 12288, 12288, 12288, 12288, 12288, 12288, 12288, 12288
.short 12288, 12288, 12288, 12288, 12288, 12288, 12288, 12288, 12288, 12288, 12288, 12288, 12288, 12288, 12288, 12288
.short 12288, 12288, 12288, 12288, 12288, 12288, 12288, 12288, 12288, 12288, 12288, 12288, 12288, 12288, 12288, 12288
.short 12288, 12288, 12288, 12288, 12288, 12288, 12288, 12288, 12288, 12288, 12288, 12288, 12288, 12288, 12288, 12288
.short 12288, 12288, 12288, 12288, 12288, 12288, 12288, 12288, 12288, 12288, 12288, 12288, 12288, 12288, 12288, 12288
.short 12288, 12288, 12288, 12288, 12288, 12288, 12288, 12288, 12288, 12288, 12288, 12288, 12288, 12288, 12288, 12288
.short 12288, 12288, 12288, 12288, 12288, 12288, 12288, 12288, 12288, 12288, 12288, 12288, 12288, 12288, 12288, 12288
.short 12288, 12288, 12288, 12288, 12288, 12288, 12288, 12288, 12288, 12288, 12288, 12288, 12288, 12288, 12288, 12288
.short 12288, 12288, 12288, 12288, 12288, 12288, 12288, 12288, 12288, 12288, 12288, 12288, 12288, 12288, 12288, 12288
.short 12288, 12288, 12288, 12288, 12288, 12288, 12288, 12288, 12288, 12288, 12288, 12288, 12288, 12288, 12288, 12288
.short 12288, 12288, 12288, 12288, 12288, 12288, 12288, 12288, 12288, 12288, 12288, 12288, 12288, 12288, 12288, 12288
.short 12288, 12288, 12288, 12288, 12288, 12288, 12288, 12288, 12288, 12288, 12288, 12288, 12288, 12288, 12288, 12288
.short 12288, 12288, 12288, 12288, 12288, 12288, 12288, 12288, 12288, 12288, 12288, 12288, 12288, 12288, 12288, 12288
.short 12288, 12288, 12288, 12288, 12288, 12288, 12288, 12288, 12288, 12288, 12288, 12288, 12288, 12288, 12288, 12288
.short 12288, 12288, 12288, 12288, 12288, 12288, 12288, 12288, 12288, 12288, 12288, 12288, 12288, 12288, 12288, 12288
.short 12288, 12288, 12288, 12288, 12288, 12288, 12288, 12288, 12288, 12288, 12288, 12288, 12288, 12288, 12288, 12288
.short 12288, 12288, 12288, 12288, 12288, 12288, 12288, 12288, 12288, 12288, 12288, 12288, 12288, 12288, 12288, 12288
.short 12288, 12288, 12288, 12288, 12288, 12288, 12288, 12288, 12288, 12288, 12288, 12288, 12288, 12288, 12288, 12288
.short 12288, 12288, 12288, 12288, 12288, 12288, 12288, 12288, 12288, 12288, 12288, 12288, 12288, 12288, 12288, 12288
.short 12288, 12288, 12288, 12288, 12288, 12288, 12288, 12288, 12288, 12288, 12288, 12288, 12288, 12288, 12288, 12288
.short 12288, 12288, 12288, 12288, 12288, 12288, 12288, 12288, 12288, 12288, 12288, 12288, 12288, 12288, 12288, 12288
.short 12288, 12288, 12288, 12288, 12288, 12288, 12288, 12288, 12288, 12288, 12288, 12288, 12288, 12288, 12288, 12288
.short 12288, 12288, 12288, 12288, 12288, 12288, 12288, 12288, 12288, 12288, 12288, 12288, 12288, 12288, 12288, 12288
.short 12288, 12288, 12288, 12288, 12288, 12288, 12288, 12288, 12288, 12288, 12288, 12288, 12288, 12288, 12288, 12288
.short 12288, 12288, 12288, 12288, 12288, 12288, 12288, 12288, 12288, 12288, 12288, 12288, 12288, 12288, 12288, 12288
.short 12288, 12288, 12288, 12288, 12288, 12288, 12288, 12288, 12288, 12288, 12288, 12288, 12288, 12288, 12288, 12288
.short 12288, 12288, 12288, 12288, 12288, 12288, 12288, 12288, 12288, 12288, 12288, 12288, 12288, 12288, 12288, 12288
.short 12288, 12288, 12288, 12288, 12288, 12288, 12288, 12288, 12288, 12288, 12288, 12288, 12288, 12288, 12288, 12288
.short 12288, 12288, 12288, 12288, 12288, 12288, 12288, 12288, 12288, 12288, 12288, 12288, 12288, 12288, 12288, 12288
.short 12288, 12288, 12288, 12288, 12288, 12288, 12288, 12288, 12288, 12288, 12288, 12288, 12288, 12288, 12288, 12288
.short 12288, 12288, 12288, 12288, 12288, 12288, 12288, 12288, 12288, 12288, 12288, 12288, 12288, 12288, 12288, 12288
.short 12288, 12288, 12288, 12288, 12288, 12288, 12288, 12288, 12288, 12288, 12288, 12288, 12288, 12288, 12288, 12288
.short 12288, 12288, 12288, 12288, 12288, 12288, 12288, 12288, 12288, 12288, 12288, 12288, 12288, 12288, 12288, 12288
.short 12288, 12288, 12288, 12288, 12288, 12288, 12288, 12288, 12288, 12288, 12288, 12288, 12288, 12288, 12288, 12288
.short 12288, 12288, 12288, 12288, 12288, 12288, 12288, 12288, 12288, 12288, 12288, 12288, 12288, 12288, 12288, 12288
.short 12288, 12288, 12288, 12288, 12288, 12288, 12288, 12288, 12288, 12288, 12288, 12288, 12288, 12288, 12288, 12288
.short 12288, 12288, 12288, 12288, 12288, 12288, 12288, 12288, 12288, 12288, 12288, 12288, 12288, 12288, 12288, 12288
.short 12288, 12288, 12288, 12288, 12288, 12288, 12288, 12288, 12288, 12288, 12288, 12288, 12288, 12288, 12288, 12288
.short 12288, 12288, 12288, 12288, 12288, 12288, 12288, 12288, 12288, 12288, 12288, 12288, 12288, 12288, 12288, 12288
.short 12288, 12288, 12288, 12288, 12288, 12288, 12288, 12288, 12288, 12288, 12288, 9216, 9216, 9216, 9216, 9216
.short 9216, 9216, 9214, 9214, 9214, 9212, 9212, 9212, 9212, 9212, 9206, 9206, 9206, 9204, 9204, 9204
.short 9204, 9204, 9198, 9198, 9198, 9196, 9196, 9196, 9196, 9196, 9190, 9190, 9190, 9188, 9188, 9188
.short 9188, 9188, 9182, 9182, 9182, 9180, 9180, 9180, 9180, 9180, 9174, 9174, 9174, 9172, 9172, 9172
.short 9172, 9172, 9166, 9166, 9166, 9164, 9164, 9164, 9164, 9164, 9158, 9158, 9158, 9156, 9156, 9156
.short 9156, 9156, 9150, 9150, 9150, 9148, 9148, 9148, 9148, 9148, 9142, 9142, 9142, 9140, 9140, 9140
.short 9140, 9140, 9134, 9134, 9134, 9132, 9132, 9132, 9132, 9132, 9126, 9126, 9126, 9124, 9124, 9124
.short 9124, 9124, 9118, 9118, 9118, 9116, 9116, 9116, 9116, 9116, 9110, 9110, 9110, 9108, 9108, 9108
.short 9108, 9108, 9102, 9102, 9102, 9100, 9100, 9100, 9100, 9100, 9094, 9094, 9094, 9092, 9092, 9092
.short 9092, 9092, 9210, 9210, 9210, 9208, 9208, 9208, 9208, 9208, 9202, 9202, 9202, 9200, 9200, 9200
.short 9200, 9200, 9194, 9194, 9194, 9192, 9192, 9192, 9192, 9192, 9186, 9186, 9186, 9184, 9184, 9184
.short 9184, 9184, 9178, 9178, 9178, 9176, 9176, 9176, 9176, 9176, 9170, 9170, 9170, 9168, 9168, 9168
.short 9168, 9168, 9162, 9162, 9162, 9160, 9160, 9160, 9160, 9160, 9154, 9154, 9154, 9152, 9152, 9152
.short 9152, 9152, 9146, 9146, 9146, 9144, 9144, 9144, 9144, 9144, 9138, 9138, 9138, 9136, 9136, 9136
.short 9136, 9136, 9130, 9130, 9130, 9128, 9128, 9128, 9128, 9128, 9122, 9122, 9122, 9120, 9120, 9120
.short 9120, 9120, 9114, 9114, 9114, 9112, 9112, 9112, 9112, 9112, 9106, 9106, 9106, 9104, 9104, 9104
.short 9104, 9104, 9098, 9098, 9098, 9096, 9096, 9096, 9096, 9096, 9090, 9090, 9090, 9088, 9088, 9088
.short 9088, 9088, 9086, 9086, 9086, 9084, 9084, 9084, 9084, 9084, 9078, 9078, 9078, 9076, 9076, 9076
.short 9076, 9076, 9070, 9070, 9070, 9068, 9068, 9068, 9068, 9068, 9062, 9062, 9062, 9060, 9060, 9060
.short 9060, 9060, 9054, 9054, 9054, 9052, 9052, 9052, 9052, 9052, 9046, 9046, 9046, 9044, 9044, 9044
.short 9044, 9044, 9038, 9038, 9038, 9036, 9036, 9036, 9036, 9036, 9030, 9030, 9030, 9028, 9028, 9028
.short 9028, 9028, 9022, 9022, 9022, 9020, 9020, 9020, 9020, 9020, 9014, 9014, 9014, 9012, 9012, 9012
.short 9012, 9012, 9006, 9006, 9006, 9004, 9004, 9004, 9004, 9004, 8998, 8998, 8998, 8996, 8996, 8996
.short 8996, 8996, 8990, 8990, 8990, 8988, 8988, 8988, 8988, 8988, 8982, 8982, 8982, 8980, 8980, 8980
.short 8980, 8980, 8974, 8974, 8974, 8972, 8972, 8972, 8972, 8972, 8966, 8966, 8966, 8964, 8964, 8964
.short 8964, 8964, 9082, 9082, 9082, 9080, 9080, 9080, 9080, 9080, 9074, 9074, 9074, 9072, 9072, 9072
.short 9072, 9072, 9066, 9066, 9066, 9064, 9064, 9064, 9064, 9064, 9058, 9058, 9058, 9056, 9056, 9056
.short 9056, 9056, 9050, 9050, 9050, 9048, 9048, 9048, 9048, 9048, 9042, 9042, 9042, 9040, 9040, 9040
.short 9040, 9040, 9034, 9034, 9034, 9032, 9032, 9032, 9032, 9032, 9026, 9026, 9026, 9024, 9024, 9024
.short 9024, 9024, 9018, 9018, 9018, 9016, 9016, 9016, 9016, 9016, 9010, 9010, 9010, 9008, 9008, 9008
.short 9008, 9008, 9002, 9002, 9002, 9000, 9000, 9000, 9000, 9000, 8994, 8994, 8994, 8992, 8992, 8992
.short 8992, 8992, 8986, 8986, 8986, 8984, 8984, 8984, 8984, 8984, 8978, 8978, 8978, 8976, 8976, 8976
.short 8976, 8976, 8970, 8970, 8970, 8968, 8968, 8968, 8968, 8968, 8962, 8962, 8962, 8960, 8960, 8960
.short 8960, 8958, 8956, 8956, 8956, 8954, 8952, 8952, 8952, 8950, 8948, 8948, 8948, 8946, 8944, 8944
.short 8944, 8942, 8940, 8940, 8940, 8938, 8936, 8936, 8936, 8934, 8932, 8932, 8932, 8930, 8928, 8928
.short 8928, 8926, 8924, 8924, 8924, 8922, 8920, 8920, 8920, 8918, 8916, 8916, 8916, 8914, 8912, 8912
.short 8912, 8910, 8908, 8908, 8908, 8906, 8904, 8904, 8904, 8902, 8900, 8900, 8900, 8898, 8896, 8896
.short 8896, 8894, 8892, 8892, 8892, 8890, 8888, 8888, 8888, 8886, 8884, 8884, 8884, 8882, 8880, 8880
.short 8880, 8878, 8876, 8876, 8876, 8874, 8872, 8872, 8872, 8870, 8868, 8868, 8868, 8866, 8864, 8864
.short 8864, 8862, 8860, 8860, 8860, 8858, 8856, 8856, 8856, 8854, 8852, 8852, 8852, 8850, 8848, 8848
.short 8848, 8846, 8844, 8844, 8844, 8842, 8840, 8840, 8840, 8838, 8836, 8836, 8836, 8834, 8832, 8832
.short 8832, 8830, 8828, 8828, 8828, 8826, 8824, 8824, 8824, 8822, 8820, 8820, 8820, 8818, 8816, 8816
.short 8816, 8814, 8812, 8812, 8812, 8810, 8808, 8808, 8808, 8806, 8804, 8804, 8804, 8802, 8800, 8800
.short 8800, 8798, 8796, 8796, 8796, 8794, 8792, 8792, 8792, 8790, 8788, 8788, 8788, 8786, 8784, 8784
.short 8784, 8782, 8780, 8780, 8780, 8778, 8776, 8776, 8776, 8774, 8772, 8772, 8772, 8770, 8768, 8768
.short 8768, 8766, 8764, 8764, 8764, 8762, 8760, 8760, 8760, 8758, 8756, 8756, 8756, 8754, 8752, 8752
.short 8752, 8750, 8748, 8748, 8748, 8746, 8744, 8744, 8744, 8742, 8740, 8740, 8740, 8738, 8736, 8736
.short 8736, 8734, 8732, 8732, 8732, 8730, 8728, 8728, 8728, 8726, 8724, 8724, 8724, 8722, 8720, 8720
.short 8720, 8718, 8716, 8716, 8716, 8714, 8712, 8712, 8712, 8710, 8708, 8708, 8708, 8706, 8704, 8704
.short 8702, 8700, 8698, 8696, 8574, 8572, 8570, 8568, 8694, 8692, 8690, 8688, 8566, 8564, 8562, 8560
.short 8686, 8684, 8682, 8680, 8558, 8556, 8554, 8552, 8678, 8676, 8674, 8672, 8550, 8548, 8546, 8544
.short 8670, 8668, 8666, 8664, 8542, 8540, 8538, 8536, 8662, 8660, 8658, 8656, 8534, 8532, 8530, 8528
.short 8654, 8652, 8650, 8648, 8526, 8524, 8522, 8520, 8646, 8644, 8642, 8640, 8518, 8516, 8514, 8512
.short 8638, 8636, 8634, 8632, 8510, 8508, 8506, 8504, 8630, 8628, 8626, 8624, 8502, 8500, 8498, 8496
.short 8622, 8620, 8618, 8616, 8494, 8492, 8490, 8488, 8614, 8612, 8610, 8608, 8486, 8484, 8482, 8480
.short 8606, 8604, 8602, 8600, 8478, 8476, 8474, 8472, 8598, 8596, 8594, 8592, 8470, 8468, 8466, 8464
.short 8590, 8588, 8586, 8584, 8462, 8460, 8458, 8456, 8582, 8580, 8578, 8576, 8454, 8452, 8450, 8448
.short 8446, 8444, 8442, 8440, 8318, 8316, 8314, 8312, 8438, 8436, 8434, 8432, 8310, 8308, 8306, 8304
.short 8430, 8428, 8426, 8424, 8302, 8300, 8298, 8296, 8422, 8420, 8418, 8416, 8294, 8292, 8290, 8288
.short 8414, 8412, 8410, 8408, 8286, 8284, 8282, 8280, 8406, 8404, 8402, 8400, 8278, 8276, 8274, 8272
.short 8398, 8396, 8394, 8392, 8270, 8268, 8266, 8264, 8390, 8388, 8386, 8384, 8262, 8260, 8258, 8256
.short 8382, 8380, 8378, 8376, 8254, 8252, 8250, 8248, 8374, 8372, 8370, 8368, 8246, 8244, 8242, 8240
.short 8366, 8364, 8362, 8360, 8238, 8236, 8234, 8232, 8358, 8356, 8354, 8352, 8230, 8228, 8226, 8224
.short 8350, 8348, 8346, 8344, 8222, 8220, 8218, 8216, 8342, 8340, 8338, 8336, 8214, 8212, 8210, 8208
.short 8334, 8332, 8330, 8328, 8206, 8204, 8202, 8200, 8326, 8324, 8322, 8320, 8198, 8196, 8194, 8192
.short 12288, 12288, 12288, 12288, 12288, 12288, 12288, 12288
.org interleave_layers__ssm_conv_s4__sliding_local_dilated__prompt_kernel + 0x10400
.size L_table, .-L_table
.section .rodata,"a"
.p2align 6
.amdhsa_kernel interleave_layers__ssm_conv_s4__sliding_local_dilated__prompt_kernel
  .amdhsa_next_free_vgpr 512
  .amdhsa_next_free_sgpr 102
  .amdhsa_accum_offset 256
  .amdhsa_group_segment_fixed_size 0
  .amdhsa_kernarg_size 120
  .amdhsa_user_sgpr_count 2
  .amdhsa_user_sgpr_kernarg_segment_ptr 1
  .amdhsa_system_sgpr_workgroup_id_x 1
.end_amdhsa_kernel
```
